```python
import torch

def _softmax(x, axis=-1):
    return torch.softmax(x, dim=axis)
def _gelu(x):
    return torch.nn.functional.gelu(x, approximate="tanh")
def _silu(x):
    return torch.nn.functional.silu(x)
def _sigmoid(x):
    return torch.sigmoid(x)
def _layernorm(x, axis=-1, eps=1e-5):
    m = x.mean(dim=axis, keepdim=True)
    v = x.var(dim=axis, keepdim=True, unbiased=False)
    return (x - m) / torch.sqrt(v + eps)
def _scatter_add(tgt, idx, src, axis=0):
    return tgt.clone().index_add_(axis, idx, src)
def _segment_sum(src, seg, n):
    out = torch.zeros((n,) + src.shape[1:], dtype=src.dtype)
    return out.index_add_(0, seg, src)
def _pad(x, pw):
    flat = tuple(v for pair in reversed(pw) for v in pair)
    return torch.nn.functional.pad(x, flat)

kernel_name = 'standalone__gqa_block_cached__decode'

def setup_inputs():

    _w = (lambda a: (lambda t: t.to(torch.bfloat16) if t.is_floating_point() else t)(torch.as_tensor(a)))
    B, Sq, D = 1, 1, 512
    Hq, Hkv, Sk, Dh = 32, 8, 65536, 128
    assert Hq % Hkv == 0, (Hq, Hkv)
    return {
        "x": _w((lambda *s: torch.randn(*s, dtype=torch.bfloat16) * 0.8)(B, Sq, D)),
        "k_cache": _w((lambda *s: torch.randn(*s, dtype=torch.bfloat16) * 0.8)(B, Hkv, Sk, Dh)),
        "v_cache": _w((lambda *s: torch.randn(*s, dtype=torch.bfloat16) * 0.05)(B, Hkv, Sk, Dh)),
        "wq": _w((lambda *s: torch.randn(*s, dtype=torch.bfloat16) * 0.8)(D, Hq * Dh) * (D ** -0.5)),
        "wo": _w((lambda *s: torch.randn(*s, dtype=torch.bfloat16) * 0.05)(Hq * Dh, D) * ((Hq * Dh) ** -0.5)),
    }

def reference(x, k_cache, v_cache, wq, wo):
    B, Sq, D = x.shape
    Hq, Dh = 32, 128
    Hkv = k_cache.shape[1]
    rep = Hq // Hkv
    q = (lambda x, *d: x.permute(*d))((x @ wq).reshape(B, Sq, Hq, Dh), 0, 2, 1, 3)
    k = (lambda x, n, axis: torch.repeat_interleave(x, n, dim=axis))(k_cache, rep, axis=1)
    v = (lambda x, n, axis: torch.repeat_interleave(x, n, dim=axis))(v_cache, rep, axis=1)
    scores = torch.einsum("bhqd,bhkd->bhqk", q, k) * (Dh ** -0.5)
    p = _softmax(scores, axis=-1)
    o = torch.einsum("bhqk,bhkd->bhqd", p, v)
    return (lambda x, *d: x.permute(*d))(o, 0, 2, 1, 3).reshape(B, Sq, Hq * Dh) @ wo
```

```asm
; @launch grid=(256,1,1) block=(256,1,1) lds=11840
.amdgcn_target "amdgcn-amd-amdhsa--gfx950"
.text
.globl standalone__gqa_block_cached__decode_kernel
.p2align 8
.type standalone__gqa_block_cached__decode_kernel,@function
standalone__gqa_block_cached__decode_kernel:
  s_cmp_ge_u32 s2, 256
  s_cbranch_scc1 L_end
  s_load_dwordx16 s[4:19], s[0:1], 0
  v_lshrrev_b32 v1, 6, v0
  v_and_b32 v0, 63, v0
  v_readfirstlane_b32 s50, v1
  s_lshr_b32 s48, s2, 5
  s_and_b32 s49, s2, 31
  s_mov_b32 s22, 0x8000000
  s_mov_b32 s23, 0x20000
  s_mov_b32 s26, 0x8000000
  s_mov_b32 s27, 0x20000
  s_mov_b32 s30, 0x20000000
  s_mov_b32 s31, 0x20000
  s_mov_b32 s34, 0x400
  s_mov_b32 s35, 0x20000
  s_mov_b32 s38, 0x400000
  s_mov_b32 s39, 0x20000
  s_mov_b32 s42, 0x400000
  s_mov_b32 s43, 0x20000
  s_mov_b32 s46, 0x400
  s_mov_b32 s47, 0x20000
  s_cmp_ge_u32 s50, 3
  s_cbranch_scc1 L_pre
  v_and_b32 v8, 15, v0
  v_lshrrev_b32 v9, 4, v0
  v_lshlrev_b32 v1, 8, v8
  v_lshl_add_u32 v1, v9, 4, v1
  v_lshlrev_b32 v2, 4, v8
  v_lshl_add_u32 v2, v9, 10, v2
  s_lshl_b32 s55, s48, 24
  s_mul_i32 s56, s48, 6291456
  s_mul_i32 s53, s49, 3
  s_add_u32 s53, s53, s50
  s_lshl_b32 s53, s53, 12
  s_add_u32 s53, s53, s56
  s_and_b32 s53, s53, 0xffffff
  s_mov_b32 s54, 0
  s_mov_b32 s57, 0x3e0293ee
  v_mov_b32 v3, 0
  v_mov_b32 v4, 0
  v_mov_b32 v5, 0xff61b1e6
  v_and_b32 v10, 1, v0
  v_lshlrev_b32 v10, 4, v10
  v_mov_b32 v11, 0xffff
  v_lshlrev_b32 v10, v10, v11
  v_and_b32 v11, 2, v0
  v_cmp_eq_u32 vcc, 0, v11
  s_nop 1
  v_cndmask_b32 v6, 0, v10, vcc
  v_xor_b32 v7, v6, v10
  v_mov_b32 v28, 0
  v_mov_b32 v29, 0
  v_mov_b32 v30, 0
  v_mov_b32 v31, 0
  v_mov_b32 v32, 0
  v_mov_b32 v33, 0
  v_mov_b32 v34, 0
  v_mov_b32 v35, 0
  v_bfe_u32 v10, v0, 2, 2
  v_lshlrev_b32 v10, 8, v10
  v_lshl_add_u32 v10, v9, 4, v10
  s_add_u32 s68, s50, 3648
  s_lshl_b32 s68, s68, 12
  s_mov_b32 s66, 0
  s_mov_b32 s67, 5
  s_mov_b32 s65, 1
  s_mov_b32 s93, 1
  s_mov_b32 s69, 0
  s_cmp_lt_u32 s49, 8
  s_cbranch_scc1 L_qs
  s_waitcnt lgkmcnt(0)
  s_mov_b64 s[20:21], s[6:7]
  s_mov_b64 s[24:25], s[8:9]
L_join:
  s_add_u32 s52, s55, s53
  s_add_u32 s53, s53, 0x60000
  s_and_b32 s53, s53, 0xffffff
  s_add_u32 s54, s54, 1
  buffer_load_dwordx4 v[52:55], v1, s[20:23], s52 offen offset:0 nt
  buffer_load_dwordx4 v[56:59], v1, s[20:23], s52 offen offset:64 nt
  buffer_load_dwordx4 v[60:63], v1, s[20:23], s52 offen offset:128 nt
  buffer_load_dwordx4 v[64:67], v1, s[20:23], s52 offen offset:192 nt
  buffer_load_dwordx4 v[68:71], v2, s[24:27], s52 offen offset:0 nt
  buffer_load_dwordx4 v[72:75], v2, s[24:27], s52 offen offset:256 nt
  buffer_load_dwordx4 v[76:79], v2, s[24:27], s52 offen offset:512 nt
  buffer_load_dwordx4 v[80:83], v2, s[24:27], s52 offen offset:768 nt
  s_mov_b64 s[28:29], s[18:19]
  s_mov_b64 s[40:41], s[12:13]
  s_load_dword s51, s[18:19], 0
  s_lshl_b32 s58, s48, 2
  s_add_u32 s58, s58, s50
  s_lshl_b32 s58, s58, 8
  s_add_u32 s58, s58, 196608
  s_add_u32 s70, s18, s58
  s_addc_u32 s71, s19, 0
  s_add_u32 s52, s55, s53
  s_add_u32 s53, s53, 0x60000
  s_and_b32 s53, s53, 0xffffff
  s_add_u32 s54, s54, 1
  buffer_load_dwordx4 v[84:87], v1, s[20:23], s52 offen offset:0 nt
  buffer_load_dwordx4 v[88:91], v1, s[20:23], s52 offen offset:64 nt
  buffer_load_dwordx4 v[92:95], v1, s[20:23], s52 offen offset:128 nt
  buffer_load_dwordx4 v[96:99], v1, s[20:23], s52 offen offset:192 nt
  buffer_load_dwordx4 v[100:103], v2, s[24:27], s52 offen offset:0 nt
  buffer_load_dwordx4 v[104:107], v2, s[24:27], s52 offen offset:256 nt
  buffer_load_dwordx4 v[108:111], v2, s[24:27], s52 offen offset:512 nt
  buffer_load_dwordx4 v[112:115], v2, s[24:27], s52 offen offset:768 nt
  s_add_u32 s52, s55, s53
  s_add_u32 s53, s53, 0x60000
  s_and_b32 s53, s53, 0xffffff
  s_add_u32 s54, s54, 1
  s_waitcnt vmcnt(12)
  buffer_load_dwordx4 v[116:119], v1, s[20:23], s52 offen offset:0 nt
  buffer_load_dwordx4 v[120:123], v1, s[20:23], s52 offen offset:64 nt
  buffer_load_dwordx4 v[124:127], v1, s[20:23], s52 offen offset:128 nt
  buffer_load_dwordx4 v[128:131], v1, s[20:23], s52 offen offset:192 nt
  s_waitcnt vmcnt(12)
  buffer_load_dwordx4 v[132:135], v2, s[24:27], s52 offen offset:0 nt
  buffer_load_dwordx4 v[136:139], v2, s[24:27], s52 offen offset:256 nt
  buffer_load_dwordx4 v[140:143], v2, s[24:27], s52 offen offset:512 nt
  buffer_load_dwordx4 v[144:147], v2, s[24:27], s52 offen offset:768 nt
  s_add_u32 s52, s55, s53
  s_add_u32 s53, s53, 0x60000
  s_and_b32 s53, s53, 0xffffff
  s_add_u32 s54, s54, 1
  s_waitcnt vmcnt(12)
  buffer_load_dwordx4 v[148:151], v1, s[20:23], s52 offen offset:0 nt
  buffer_load_dwordx4 v[152:155], v1, s[20:23], s52 offen offset:64 nt
  buffer_load_dwordx4 v[156:159], v1, s[20:23], s52 offen offset:128 nt
  buffer_load_dwordx4 v[160:163], v1, s[20:23], s52 offen offset:192 nt
  s_waitcnt vmcnt(12)
  buffer_load_dwordx4 v[164:167], v2, s[24:27], s52 offen offset:0 nt
  buffer_load_dwordx4 v[168:171], v2, s[24:27], s52 offen offset:256 nt
  buffer_load_dwordx4 v[172:175], v2, s[24:27], s52 offen offset:512 nt
  buffer_load_dwordx4 v[176:179], v2, s[24:27], s52 offen offset:768 nt
  s_add_u32 s52, s55, s53
  s_add_u32 s53, s53, 0x60000
  s_and_b32 s53, s53, 0xffffff
  s_add_u32 s54, s54, 1
  s_waitcnt vmcnt(12)
  buffer_load_dwordx4 v[180:183], v1, s[20:23], s52 offen offset:0 nt
  buffer_load_dwordx4 v[184:187], v1, s[20:23], s52 offen offset:64 nt
  buffer_load_dwordx4 v[188:191], v1, s[20:23], s52 offen offset:128 nt
  buffer_load_dwordx4 v[192:195], v1, s[20:23], s52 offen offset:192 nt
  s_waitcnt vmcnt(12)
  buffer_load_dwordx4 v[196:199], v2, s[24:27], s52 offen offset:0 nt
  buffer_load_dwordx4 v[200:203], v2, s[24:27], s52 offen offset:256 nt
  buffer_load_dwordx4 v[204:207], v2, s[24:27], s52 offen offset:512 nt
  buffer_load_dwordx4 v[208:211], v2, s[24:27], s52 offen offset:768 nt
  s_barrier
  ds_read_b128 v[36:39], v10 offset:0
  ds_read_b128 v[40:43], v10 offset:64
  ds_read_b128 v[44:47], v10 offset:128
  ds_read_b128 v[48:51], v10 offset:192
  s_waitcnt lgkmcnt(0)
  s_add_u32 s51, s51, 1
L_p1loop:
  s_waitcnt vmcnt(36)
  v_mfma_f32_16x16x32_bf16 v[12:15], v[52:55], v[36:39], 0
  v_mfma_f32_16x16x32_bf16 v[12:15], v[56:59], v[40:43], v[12:15]
  v_mfma_f32_16x16x32_bf16 v[12:15], v[60:63], v[44:47], v[12:15]
  v_mfma_f32_16x16x32_bf16 v[12:15], v[64:67], v[48:51], v[12:15]
  s_add_u32 s52, s55, s53
  s_add_u32 s53, s53, 0x60000
  s_and_b32 s53, s53, 0xffffff
  s_add_u32 s54, s54, 1
  s_add_u32 s67, s67, 1
L_p1iss0:
  buffer_load_dwordx4 v[52:55], v1, s[20:23], s52 offen offset:0 nt
  buffer_load_dwordx4 v[56:59], v1, s[20:23], s52 offen offset:64 nt
  buffer_load_dwordx4 v[60:63], v1, s[20:23], s52 offen offset:128 nt
  buffer_load_dwordx4 v[64:67], v1, s[20:23], s52 offen offset:192 nt
  v_fma_f32 v16, v12, s57, v3
  v_fma_f32 v17, v13, s57, v3
  v_fma_f32 v18, v14, s57, v3
  v_fma_f32 v19, v15, s57, v3
  v_max3_f32 v8, v16, v17, v18
  v_max_f32 v8, v8, v19
  v_cmp_gt_f32 vcc, v8, v5
  s_cbranch_vccnz L_p1rare0
L_p1back0:
  v_exp_f32 v16, v16
  v_exp_f32 v17, v17
  v_exp_f32 v18, v18
  v_exp_f32 v19, v19
  v_add_f32 v9, v16, v17
  v_add_f32 v10, v18, v19
  v_cvt_pk_bf16_f32 v16, v16, v16
  v_cvt_pk_bf16_f32 v17, v17, v17
  v_cvt_pk_bf16_f32 v18, v18, v18
  v_cvt_pk_bf16_f32 v19, v19, v19
  v_add_f32 v4, v4, v9
  v_and_b32 v20, v16, v6
  v_and_b32 v21, v16, v7
  v_and_b32 v22, v17, v6
  v_and_b32 v23, v17, v7
  v_and_b32 v24, v18, v6
  v_and_b32 v25, v18, v7
  v_and_b32 v26, v19, v6
  v_and_b32 v27, v19, v7
  v_add_f32 v4, v4, v10
  s_waitcnt vmcnt(36)
  v_mfma_f32_16x16x16_bf16 v[28:31], v[68:69], v[20:21], v[28:31]
  v_mfma_f32_16x16x16_bf16 v[32:35], v[70:71], v[20:21], v[32:35]
  buffer_load_dwordx4 v[68:71], v2, s[24:27], s52 offen offset:0 nt
  v_mfma_f32_16x16x16_bf16 v[28:31], v[72:73], v[22:23], v[28:31]
  v_mfma_f32_16x16x16_bf16 v[32:35], v[74:75], v[22:23], v[32:35]
  buffer_load_dwordx4 v[72:75], v2, s[24:27], s52 offen offset:256 nt
  v_mfma_f32_16x16x16_bf16 v[28:31], v[76:77], v[24:25], v[28:31]
  v_mfma_f32_16x16x16_bf16 v[32:35], v[78:79], v[24:25], v[32:35]
  buffer_load_dwordx4 v[76:79], v2, s[24:27], s52 offen offset:512 nt
  v_mfma_f32_16x16x16_bf16 v[28:31], v[80:81], v[26:27], v[28:31]
  v_mfma_f32_16x16x16_bf16 v[32:35], v[82:83], v[26:27], v[32:35]
  buffer_load_dwordx4 v[80:83], v2, s[24:27], s52 offen offset:768 nt
  s_add_u32 s66, s66, 1
  s_waitcnt vmcnt(36)
  v_mfma_f32_16x16x32_bf16 v[12:15], v[84:87], v[36:39], 0
  v_mfma_f32_16x16x32_bf16 v[12:15], v[88:91], v[40:43], v[12:15]
  v_mfma_f32_16x16x32_bf16 v[12:15], v[92:95], v[44:47], v[12:15]
  v_mfma_f32_16x16x32_bf16 v[12:15], v[96:99], v[48:51], v[12:15]
  s_add_u32 s52, s55, s53
  s_add_u32 s53, s53, 0x60000
  s_and_b32 s53, s53, 0xffffff
  s_add_u32 s54, s54, 1
  s_add_u32 s67, s67, 1
L_p1iss1:
  buffer_load_dwordx4 v[84:87], v1, s[20:23], s52 offen offset:0 nt
  buffer_load_dwordx4 v[88:91], v1, s[20:23], s52 offen offset:64 nt
  buffer_load_dwordx4 v[92:95], v1, s[20:23], s52 offen offset:128 nt
  buffer_load_dwordx4 v[96:99], v1, s[20:23], s52 offen offset:192 nt
  v_fma_f32 v16, v12, s57, v3
  v_fma_f32 v17, v13, s57, v3
  v_fma_f32 v18, v14, s57, v3
  v_fma_f32 v19, v15, s57, v3
  v_max3_f32 v8, v16, v17, v18
  v_max_f32 v8, v8, v19
  v_cmp_gt_f32 vcc, v8, v5
  s_cbranch_vccnz L_p1rare1
L_p1back1:
  v_exp_f32 v16, v16
  v_exp_f32 v17, v17
  v_exp_f32 v18, v18
  v_exp_f32 v19, v19
  v_add_f32 v9, v16, v17
  v_add_f32 v10, v18, v19
  v_cvt_pk_bf16_f32 v16, v16, v16
  v_cvt_pk_bf16_f32 v17, v17, v17
  v_cvt_pk_bf16_f32 v18, v18, v18
  v_cvt_pk_bf16_f32 v19, v19, v19
  v_add_f32 v4, v4, v9
  v_and_b32 v20, v16, v6
  v_and_b32 v21, v16, v7
  v_and_b32 v22, v17, v6
  v_and_b32 v23, v17, v7
  v_and_b32 v24, v18, v6
  v_and_b32 v25, v18, v7
  v_and_b32 v26, v19, v6
  v_and_b32 v27, v19, v7
  v_add_f32 v4, v4, v10
  s_waitcnt vmcnt(36)
  v_mfma_f32_16x16x16_bf16 v[28:31], v[100:101], v[20:21], v[28:31]
  v_mfma_f32_16x16x16_bf16 v[32:35], v[102:103], v[20:21], v[32:35]
  buffer_load_dwordx4 v[100:103], v2, s[24:27], s52 offen offset:0 nt
  v_mfma_f32_16x16x16_bf16 v[28:31], v[104:105], v[22:23], v[28:31]
  v_mfma_f32_16x16x16_bf16 v[32:35], v[106:107], v[22:23], v[32:35]
  buffer_load_dwordx4 v[104:107], v2, s[24:27], s52 offen offset:256 nt
  v_mfma_f32_16x16x16_bf16 v[28:31], v[108:109], v[24:25], v[28:31]
  v_mfma_f32_16x16x16_bf16 v[32:35], v[110:111], v[24:25], v[32:35]
  buffer_load_dwordx4 v[108:111], v2, s[24:27], s52 offen offset:512 nt
  v_mfma_f32_16x16x16_bf16 v[28:31], v[112:113], v[26:27], v[28:31]
  v_mfma_f32_16x16x16_bf16 v[32:35], v[114:115], v[26:27], v[32:35]
  buffer_load_dwordx4 v[112:115], v2, s[24:27], s52 offen offset:768 nt
  s_add_u32 s66, s66, 1
  s_waitcnt vmcnt(36)
  v_mfma_f32_16x16x32_bf16 v[12:15], v[116:119], v[36:39], 0
  v_mfma_f32_16x16x32_bf16 v[12:15], v[120:123], v[40:43], v[12:15]
  v_mfma_f32_16x16x32_bf16 v[12:15], v[124:127], v[44:47], v[12:15]
  v_mfma_f32_16x16x32_bf16 v[12:15], v[128:131], v[48:51], v[12:15]
  s_add_u32 s52, s55, s53
  s_add_u32 s53, s53, 0x60000
  s_and_b32 s53, s53, 0xffffff
  s_add_u32 s54, s54, 1
  s_add_u32 s67, s67, 1
L_p1iss2:
  buffer_load_dwordx4 v[116:119], v1, s[20:23], s52 offen offset:0 nt
  buffer_load_dwordx4 v[120:123], v1, s[20:23], s52 offen offset:64 nt
  buffer_load_dwordx4 v[124:127], v1, s[20:23], s52 offen offset:128 nt
  buffer_load_dwordx4 v[128:131], v1, s[20:23], s52 offen offset:192 nt
  v_fma_f32 v16, v12, s57, v3
  v_fma_f32 v17, v13, s57, v3
  v_fma_f32 v18, v14, s57, v3
  v_fma_f32 v19, v15, s57, v3
  v_max3_f32 v8, v16, v17, v18
  v_max_f32 v8, v8, v19
  v_cmp_gt_f32 vcc, v8, v5
  s_cbranch_vccnz L_p1rare2
L_p1back2:
  v_exp_f32 v16, v16
  v_exp_f32 v17, v17
  v_exp_f32 v18, v18
  v_exp_f32 v19, v19
  v_add_f32 v9, v16, v17
  v_add_f32 v10, v18, v19
  v_cvt_pk_bf16_f32 v16, v16, v16
  v_cvt_pk_bf16_f32 v17, v17, v17
  v_cvt_pk_bf16_f32 v18, v18, v18
  v_cvt_pk_bf16_f32 v19, v19, v19
  v_add_f32 v4, v4, v9
  v_and_b32 v20, v16, v6
  v_and_b32 v21, v16, v7
  v_and_b32 v22, v17, v6
  v_and_b32 v23, v17, v7
  v_and_b32 v24, v18, v6
  v_and_b32 v25, v18, v7
  v_and_b32 v26, v19, v6
  v_and_b32 v27, v19, v7
  v_add_f32 v4, v4, v10
  s_waitcnt vmcnt(36)
  v_mfma_f32_16x16x16_bf16 v[28:31], v[132:133], v[20:21], v[28:31]
  v_mfma_f32_16x16x16_bf16 v[32:35], v[134:135], v[20:21], v[32:35]
  buffer_load_dwordx4 v[132:135], v2, s[24:27], s52 offen offset:0 nt
  v_mfma_f32_16x16x16_bf16 v[28:31], v[136:137], v[22:23], v[28:31]
  v_mfma_f32_16x16x16_bf16 v[32:35], v[138:139], v[22:23], v[32:35]
  buffer_load_dwordx4 v[136:139], v2, s[24:27], s52 offen offset:256 nt
  v_mfma_f32_16x16x16_bf16 v[28:31], v[140:141], v[24:25], v[28:31]
  v_mfma_f32_16x16x16_bf16 v[32:35], v[142:143], v[24:25], v[32:35]
  buffer_load_dwordx4 v[140:143], v2, s[24:27], s52 offen offset:512 nt
  v_mfma_f32_16x16x16_bf16 v[28:31], v[144:145], v[26:27], v[28:31]
  v_mfma_f32_16x16x16_bf16 v[32:35], v[146:147], v[26:27], v[32:35]
  buffer_load_dwordx4 v[144:147], v2, s[24:27], s52 offen offset:768 nt
  s_add_u32 s66, s66, 1
  s_waitcnt vmcnt(36)
  v_mfma_f32_16x16x32_bf16 v[12:15], v[148:151], v[36:39], 0
  v_mfma_f32_16x16x32_bf16 v[12:15], v[152:155], v[40:43], v[12:15]
  v_mfma_f32_16x16x32_bf16 v[12:15], v[156:159], v[44:47], v[12:15]
  v_mfma_f32_16x16x32_bf16 v[12:15], v[160:163], v[48:51], v[12:15]
  s_add_u32 s52, s55, s53
  s_add_u32 s53, s53, 0x60000
  s_and_b32 s53, s53, 0xffffff
  s_add_u32 s54, s54, 1
  s_add_u32 s67, s67, 1
L_p1iss3:
  buffer_load_dwordx4 v[148:151], v1, s[20:23], s52 offen offset:0 nt
  buffer_load_dwordx4 v[152:155], v1, s[20:23], s52 offen offset:64 nt
  buffer_load_dwordx4 v[156:159], v1, s[20:23], s52 offen offset:128 nt
  buffer_load_dwordx4 v[160:163], v1, s[20:23], s52 offen offset:192 nt
  v_fma_f32 v16, v12, s57, v3
  v_fma_f32 v17, v13, s57, v3
  v_fma_f32 v18, v14, s57, v3
  v_fma_f32 v19, v15, s57, v3
  v_max3_f32 v8, v16, v17, v18
  v_max_f32 v8, v8, v19
  v_cmp_gt_f32 vcc, v8, v5
  s_cbranch_vccnz L_p1rare3
L_p1back3:
  v_exp_f32 v16, v16
  v_exp_f32 v17, v17
  v_exp_f32 v18, v18
  v_exp_f32 v19, v19
  v_add_f32 v9, v16, v17
  v_add_f32 v10, v18, v19
  v_cvt_pk_bf16_f32 v16, v16, v16
  v_cvt_pk_bf16_f32 v17, v17, v17
  v_cvt_pk_bf16_f32 v18, v18, v18
  v_cvt_pk_bf16_f32 v19, v19, v19
  v_add_f32 v4, v4, v9
  v_and_b32 v20, v16, v6
  v_and_b32 v21, v16, v7
  v_and_b32 v22, v17, v6
  v_and_b32 v23, v17, v7
  v_and_b32 v24, v18, v6
  v_and_b32 v25, v18, v7
  v_and_b32 v26, v19, v6
  v_and_b32 v27, v19, v7
  v_add_f32 v4, v4, v10
  s_waitcnt vmcnt(36)
  v_mfma_f32_16x16x16_bf16 v[28:31], v[164:165], v[20:21], v[28:31]
  v_mfma_f32_16x16x16_bf16 v[32:35], v[166:167], v[20:21], v[32:35]
  buffer_load_dwordx4 v[164:167], v2, s[24:27], s52 offen offset:0 nt
  v_mfma_f32_16x16x16_bf16 v[28:31], v[168:169], v[22:23], v[28:31]
  v_mfma_f32_16x16x16_bf16 v[32:35], v[170:171], v[22:23], v[32:35]
  buffer_load_dwordx4 v[168:171], v2, s[24:27], s52 offen offset:256 nt
  v_mfma_f32_16x16x16_bf16 v[28:31], v[172:173], v[24:25], v[28:31]
  v_mfma_f32_16x16x16_bf16 v[32:35], v[174:175], v[24:25], v[32:35]
  buffer_load_dwordx4 v[172:175], v2, s[24:27], s52 offen offset:512 nt
  v_mfma_f32_16x16x16_bf16 v[28:31], v[176:177], v[26:27], v[28:31]
  v_mfma_f32_16x16x16_bf16 v[32:35], v[178:179], v[26:27], v[32:35]
  buffer_load_dwordx4 v[176:179], v2, s[24:27], s52 offen offset:768 nt
  s_add_u32 s66, s66, 1
  s_waitcnt vmcnt(36)
  v_mfma_f32_16x16x32_bf16 v[12:15], v[180:183], v[36:39], 0
  v_mfma_f32_16x16x32_bf16 v[12:15], v[184:187], v[40:43], v[12:15]
  v_mfma_f32_16x16x32_bf16 v[12:15], v[188:191], v[44:47], v[12:15]
  v_mfma_f32_16x16x32_bf16 v[12:15], v[192:195], v[48:51], v[12:15]
  s_add_u32 s52, s55, s53
  s_add_u32 s53, s53, 0x60000
  s_and_b32 s53, s53, 0xffffff
  s_add_u32 s54, s54, 1
  s_add_u32 s67, s67, 1
L_p1iss4:
  buffer_load_dwordx4 v[180:183], v1, s[20:23], s52 offen offset:0 nt
  buffer_load_dwordx4 v[184:187], v1, s[20:23], s52 offen offset:64 nt
  buffer_load_dwordx4 v[188:191], v1, s[20:23], s52 offen offset:128 nt
  buffer_load_dwordx4 v[192:195], v1, s[20:23], s52 offen offset:192 nt
  v_fma_f32 v16, v12, s57, v3
  v_fma_f32 v17, v13, s57, v3
  v_fma_f32 v18, v14, s57, v3
  v_fma_f32 v19, v15, s57, v3
  v_max3_f32 v8, v16, v17, v18
  v_max_f32 v8, v8, v19
  v_cmp_gt_f32 vcc, v8, v5
  s_cbranch_vccnz L_p1rare4
L_p1back4:
  v_exp_f32 v16, v16
  v_exp_f32 v17, v17
  v_exp_f32 v18, v18
  v_exp_f32 v19, v19
  v_add_f32 v9, v16, v17
  v_add_f32 v10, v18, v19
  v_cvt_pk_bf16_f32 v16, v16, v16
  v_cvt_pk_bf16_f32 v17, v17, v17
  v_cvt_pk_bf16_f32 v18, v18, v18
  v_cvt_pk_bf16_f32 v19, v19, v19
  v_add_f32 v4, v4, v9
  v_and_b32 v20, v16, v6
  v_and_b32 v21, v16, v7
  v_and_b32 v22, v17, v6
  v_and_b32 v23, v17, v7
  v_and_b32 v24, v18, v6
  v_and_b32 v25, v18, v7
  v_and_b32 v26, v19, v6
  v_and_b32 v27, v19, v7
  v_add_f32 v4, v4, v10
  s_waitcnt vmcnt(36)
  v_mfma_f32_16x16x16_bf16 v[28:31], v[196:197], v[20:21], v[28:31]
  v_mfma_f32_16x16x16_bf16 v[32:35], v[198:199], v[20:21], v[32:35]
  buffer_load_dwordx4 v[196:199], v2, s[24:27], s52 offen offset:0 nt
  v_mfma_f32_16x16x16_bf16 v[28:31], v[200:201], v[22:23], v[28:31]
  v_mfma_f32_16x16x16_bf16 v[32:35], v[202:203], v[22:23], v[32:35]
  buffer_load_dwordx4 v[200:203], v2, s[24:27], s52 offen offset:256 nt
  v_mfma_f32_16x16x16_bf16 v[28:31], v[204:205], v[24:25], v[28:31]
  v_mfma_f32_16x16x16_bf16 v[32:35], v[206:207], v[24:25], v[32:35]
  buffer_load_dwordx4 v[204:207], v2, s[24:27], s52 offen offset:512 nt
  v_mfma_f32_16x16x16_bf16 v[28:31], v[208:209], v[26:27], v[28:31]
  v_mfma_f32_16x16x16_bf16 v[32:35], v[210:211], v[26:27], v[32:35]
  buffer_load_dwordx4 v[208:211], v2, s[24:27], s52 offen offset:768 nt
  s_add_u32 s66, s66, 1
  s_cmp_lt_u32 s66, 15
  s_cbranch_scc1 L_p1loop
L_loop:
  s_cmp_eq_u32 s66, s67
  s_cbranch_scc1 L_exit
  s_waitcnt vmcnt(12)
  v_mfma_f32_16x16x32_bf16 v[12:15], v[52:55], v[36:39], 0
  v_mfma_f32_16x16x32_bf16 v[12:15], v[56:59], v[40:43], v[12:15]
  v_mfma_f32_16x16x32_bf16 v[12:15], v[60:63], v[44:47], v[12:15]
  v_mfma_f32_16x16x32_bf16 v[12:15], v[64:67], v[48:51], v[12:15]
  s_cmp_lt_u32 s66, 18
  s_cbranch_scc1 L_skipk0
  s_cmp_ge_u32 s54, 38
  s_cbranch_scc1 L_dyn0
  s_add_u32 s52, s55, s53
  s_add_u32 s53, s53, 0x60000
  s_and_b32 s53, s53, 0xffffff
  s_add_u32 s54, s54, 1
  s_add_u32 s67, s67, 1
L_iss0:
  buffer_load_dwordx4 v[116:119], v1, s[20:23], s52 offen offset:0 nt
  buffer_load_dwordx4 v[120:123], v1, s[20:23], s52 offen offset:64 nt
  buffer_load_dwordx4 v[124:127], v1, s[20:23], s52 offen offset:128 nt
  buffer_load_dwordx4 v[128:131], v1, s[20:23], s52 offen offset:192 nt
L_skipk0:
  s_nop 5
  v_fma_f32 v16, v12, s57, v3
  v_fma_f32 v17, v13, s57, v3
  v_fma_f32 v18, v14, s57, v3
  v_fma_f32 v19, v15, s57, v3
  v_max3_f32 v8, v16, v17, v18
  v_max_f32 v8, v8, v19
  v_cmp_gt_f32 vcc, v8, v5
  s_cbranch_vccnz L_rare0
L_back0:
  v_exp_f32 v16, v16
  v_exp_f32 v17, v17
  v_exp_f32 v18, v18
  v_exp_f32 v19, v19
  v_add_f32 v9, v16, v17
  v_add_f32 v10, v18, v19
  v_cvt_pk_bf16_f32 v16, v16, v16
  v_cvt_pk_bf16_f32 v17, v17, v17
  v_cvt_pk_bf16_f32 v18, v18, v18
  v_cvt_pk_bf16_f32 v19, v19, v19
  v_add_f32 v4, v4, v9
  v_and_b32 v20, v16, v6
  v_and_b32 v21, v16, v7
  v_and_b32 v22, v17, v6
  v_and_b32 v23, v17, v7
  v_and_b32 v24, v18, v6
  v_and_b32 v25, v18, v7
  v_and_b32 v26, v19, v6
  v_and_b32 v27, v19, v7
  v_add_f32 v4, v4, v10
  s_waitcnt vmcnt(12)
  v_mfma_f32_16x16x16_bf16 v[28:31], v[68:69], v[20:21], v[28:31]
  v_mfma_f32_16x16x16_bf16 v[32:35], v[70:71], v[20:21], v[32:35]
  s_nop 0
  v_mfma_f32_16x16x16_bf16 v[28:31], v[72:73], v[22:23], v[28:31]
  v_mfma_f32_16x16x16_bf16 v[32:35], v[74:75], v[22:23], v[32:35]
  s_nop 0
  v_mfma_f32_16x16x16_bf16 v[28:31], v[76:77], v[24:25], v[28:31]
  v_mfma_f32_16x16x16_bf16 v[32:35], v[78:79], v[24:25], v[32:35]
  s_nop 0
  v_mfma_f32_16x16x16_bf16 v[28:31], v[80:81], v[26:27], v[28:31]
  v_mfma_f32_16x16x16_bf16 v[32:35], v[82:83], v[26:27], v[32:35]
  s_cmp_lt_u32 s66, 18
  s_cbranch_scc1 L_skipv0
  buffer_load_dwordx4 v[132:135], v2, s[24:27], s52 offen offset:0 nt
  buffer_load_dwordx4 v[136:139], v2, s[24:27], s52 offen offset:256 nt
  buffer_load_dwordx4 v[140:143], v2, s[24:27], s52 offen offset:512 nt
  buffer_load_dwordx4 v[144:147], v2, s[24:27], s52 offen offset:768 nt
L_skipv0:
  s_add_u32 s66, s66, 1
  s_cmp_eq_u32 s66, s67
  s_cbranch_scc1 L_exit
  s_waitcnt vmcnt(12)
  v_mfma_f32_16x16x32_bf16 v[12:15], v[84:87], v[36:39], 0
  v_mfma_f32_16x16x32_bf16 v[12:15], v[88:91], v[40:43], v[12:15]
  v_mfma_f32_16x16x32_bf16 v[12:15], v[92:95], v[44:47], v[12:15]
  v_mfma_f32_16x16x32_bf16 v[12:15], v[96:99], v[48:51], v[12:15]
  s_cmp_lt_u32 s66, 18
  s_cbranch_scc1 L_skipk1
  s_cmp_ge_u32 s54, 38
  s_cbranch_scc1 L_dyn1
  s_add_u32 s52, s55, s53
  s_add_u32 s53, s53, 0x60000
  s_and_b32 s53, s53, 0xffffff
  s_add_u32 s54, s54, 1
  s_add_u32 s67, s67, 1
L_iss1:
  buffer_load_dwordx4 v[148:151], v1, s[20:23], s52 offen offset:0 nt
  buffer_load_dwordx4 v[152:155], v1, s[20:23], s52 offen offset:64 nt
  buffer_load_dwordx4 v[156:159], v1, s[20:23], s52 offen offset:128 nt
  buffer_load_dwordx4 v[160:163], v1, s[20:23], s52 offen offset:192 nt
L_skipk1:
  s_nop 5
  v_fma_f32 v16, v12, s57, v3
  v_fma_f32 v17, v13, s57, v3
  v_fma_f32 v18, v14, s57, v3
  v_fma_f32 v19, v15, s57, v3
  v_max3_f32 v8, v16, v17, v18
  v_max_f32 v8, v8, v19
  v_cmp_gt_f32 vcc, v8, v5
  s_cbranch_vccnz L_rare1
L_back1:
  v_exp_f32 v16, v16
  v_exp_f32 v17, v17
  v_exp_f32 v18, v18
  v_exp_f32 v19, v19
  v_add_f32 v9, v16, v17
  v_add_f32 v10, v18, v19
  v_cvt_pk_bf16_f32 v16, v16, v16
  v_cvt_pk_bf16_f32 v17, v17, v17
  v_cvt_pk_bf16_f32 v18, v18, v18
  v_cvt_pk_bf16_f32 v19, v19, v19
  v_add_f32 v4, v4, v9
  v_and_b32 v20, v16, v6
  v_and_b32 v21, v16, v7
  v_and_b32 v22, v17, v6
  v_and_b32 v23, v17, v7
  v_and_b32 v24, v18, v6
  v_and_b32 v25, v18, v7
  v_and_b32 v26, v19, v6
  v_and_b32 v27, v19, v7
  v_add_f32 v4, v4, v10
  s_waitcnt vmcnt(12)
  v_mfma_f32_16x16x16_bf16 v[28:31], v[100:101], v[20:21], v[28:31]
  v_mfma_f32_16x16x16_bf16 v[32:35], v[102:103], v[20:21], v[32:35]
  s_nop 0
  v_mfma_f32_16x16x16_bf16 v[28:31], v[104:105], v[22:23], v[28:31]
  v_mfma_f32_16x16x16_bf16 v[32:35], v[106:107], v[22:23], v[32:35]
  s_nop 0
  v_mfma_f32_16x16x16_bf16 v[28:31], v[108:109], v[24:25], v[28:31]
  v_mfma_f32_16x16x16_bf16 v[32:35], v[110:111], v[24:25], v[32:35]
  s_nop 0
  v_mfma_f32_16x16x16_bf16 v[28:31], v[112:113], v[26:27], v[28:31]
  v_mfma_f32_16x16x16_bf16 v[32:35], v[114:115], v[26:27], v[32:35]
  s_cmp_lt_u32 s66, 18
  s_cbranch_scc1 L_skipv1
  buffer_load_dwordx4 v[164:167], v2, s[24:27], s52 offen offset:0 nt
  buffer_load_dwordx4 v[168:171], v2, s[24:27], s52 offen offset:256 nt
  buffer_load_dwordx4 v[172:175], v2, s[24:27], s52 offen offset:512 nt
  buffer_load_dwordx4 v[176:179], v2, s[24:27], s52 offen offset:768 nt
L_skipv1:
  s_add_u32 s66, s66, 1
  s_cmp_eq_u32 s66, s67
  s_cbranch_scc1 L_exit
  s_waitcnt vmcnt(12)
  v_mfma_f32_16x16x32_bf16 v[12:15], v[116:119], v[36:39], 0
  v_mfma_f32_16x16x32_bf16 v[12:15], v[120:123], v[40:43], v[12:15]
  v_mfma_f32_16x16x32_bf16 v[12:15], v[124:127], v[44:47], v[12:15]
  v_mfma_f32_16x16x32_bf16 v[12:15], v[128:131], v[48:51], v[12:15]
  s_cmp_lt_u32 s66, 18
  s_cbranch_scc1 L_skipk2
  s_cmp_ge_u32 s54, 38
  s_cbranch_scc1 L_dyn2
  s_add_u32 s52, s55, s53
  s_add_u32 s53, s53, 0x60000
  s_and_b32 s53, s53, 0xffffff
  s_add_u32 s54, s54, 1
  s_add_u32 s67, s67, 1
L_iss2:
  buffer_load_dwordx4 v[180:183], v1, s[20:23], s52 offen offset:0 nt
  buffer_load_dwordx4 v[184:187], v1, s[20:23], s52 offen offset:64 nt
  buffer_load_dwordx4 v[188:191], v1, s[20:23], s52 offen offset:128 nt
  buffer_load_dwordx4 v[192:195], v1, s[20:23], s52 offen offset:192 nt
L_skipk2:
  s_nop 5
  v_fma_f32 v16, v12, s57, v3
  v_fma_f32 v17, v13, s57, v3
  v_fma_f32 v18, v14, s57, v3
  v_fma_f32 v19, v15, s57, v3
  v_max3_f32 v8, v16, v17, v18
  v_max_f32 v8, v8, v19
  v_cmp_gt_f32 vcc, v8, v5
  s_cbranch_vccnz L_rare2
L_back2:
  v_exp_f32 v16, v16
  v_exp_f32 v17, v17
  v_exp_f32 v18, v18
  v_exp_f32 v19, v19
  v_add_f32 v9, v16, v17
  v_add_f32 v10, v18, v19
  v_cvt_pk_bf16_f32 v16, v16, v16
  v_cvt_pk_bf16_f32 v17, v17, v17
  v_cvt_pk_bf16_f32 v18, v18, v18
  v_cvt_pk_bf16_f32 v19, v19, v19
  v_add_f32 v4, v4, v9
  v_and_b32 v20, v16, v6
  v_and_b32 v21, v16, v7
  v_and_b32 v22, v17, v6
  v_and_b32 v23, v17, v7
  v_and_b32 v24, v18, v6
  v_and_b32 v25, v18, v7
  v_and_b32 v26, v19, v6
  v_and_b32 v27, v19, v7
  v_add_f32 v4, v4, v10
  s_waitcnt vmcnt(12)
  v_mfma_f32_16x16x16_bf16 v[28:31], v[132:133], v[20:21], v[28:31]
  v_mfma_f32_16x16x16_bf16 v[32:35], v[134:135], v[20:21], v[32:35]
  s_nop 0
  v_mfma_f32_16x16x16_bf16 v[28:31], v[136:137], v[22:23], v[28:31]
  v_mfma_f32_16x16x16_bf16 v[32:35], v[138:139], v[22:23], v[32:35]
  s_nop 0
  v_mfma_f32_16x16x16_bf16 v[28:31], v[140:141], v[24:25], v[28:31]
  v_mfma_f32_16x16x16_bf16 v[32:35], v[142:143], v[24:25], v[32:35]
  s_nop 0
  v_mfma_f32_16x16x16_bf16 v[28:31], v[144:145], v[26:27], v[28:31]
  v_mfma_f32_16x16x16_bf16 v[32:35], v[146:147], v[26:27], v[32:35]
  s_cmp_lt_u32 s66, 18
  s_cbranch_scc1 L_skipv2
  buffer_load_dwordx4 v[196:199], v2, s[24:27], s52 offen offset:0 nt
  buffer_load_dwordx4 v[200:203], v2, s[24:27], s52 offen offset:256 nt
  buffer_load_dwordx4 v[204:207], v2, s[24:27], s52 offen offset:512 nt
  buffer_load_dwordx4 v[208:211], v2, s[24:27], s52 offen offset:768 nt
L_skipv2:
  s_add_u32 s66, s66, 1
  s_cmp_eq_u32 s66, s67
  s_cbranch_scc1 L_exit
  s_waitcnt vmcnt(12)
  v_mfma_f32_16x16x32_bf16 v[12:15], v[148:151], v[36:39], 0
  v_mfma_f32_16x16x32_bf16 v[12:15], v[152:155], v[40:43], v[12:15]
  v_mfma_f32_16x16x32_bf16 v[12:15], v[156:159], v[44:47], v[12:15]
  v_mfma_f32_16x16x32_bf16 v[12:15], v[160:163], v[48:51], v[12:15]
  s_cmp_ge_u32 s54, 38
  s_cbranch_scc1 L_dyn3
  s_add_u32 s52, s55, s53
  s_add_u32 s53, s53, 0x60000
  s_and_b32 s53, s53, 0xffffff
  s_add_u32 s54, s54, 1
  s_add_u32 s67, s67, 1
L_iss3:
  buffer_load_dwordx4 v[52:55], v1, s[20:23], s52 offen offset:0 nt
  buffer_load_dwordx4 v[56:59], v1, s[20:23], s52 offen offset:64 nt
  buffer_load_dwordx4 v[60:63], v1, s[20:23], s52 offen offset:128 nt
  buffer_load_dwordx4 v[64:67], v1, s[20:23], s52 offen offset:192 nt
  v_fma_f32 v16, v12, s57, v3
  v_fma_f32 v17, v13, s57, v3
  v_fma_f32 v18, v14, s57, v3
  v_fma_f32 v19, v15, s57, v3
  v_max3_f32 v8, v16, v17, v18
  v_max_f32 v8, v8, v19
  v_cmp_gt_f32 vcc, v8, v5
  s_cbranch_vccnz L_rare3
L_back3:
  v_exp_f32 v16, v16
  v_exp_f32 v17, v17
  v_exp_f32 v18, v18
  v_exp_f32 v19, v19
  v_add_f32 v9, v16, v17
  v_add_f32 v10, v18, v19
  v_cvt_pk_bf16_f32 v16, v16, v16
  v_cvt_pk_bf16_f32 v17, v17, v17
  v_cvt_pk_bf16_f32 v18, v18, v18
  v_cvt_pk_bf16_f32 v19, v19, v19
  v_add_f32 v4, v4, v9
  v_and_b32 v20, v16, v6
  v_and_b32 v21, v16, v7
  v_and_b32 v22, v17, v6
  v_and_b32 v23, v17, v7
  v_and_b32 v24, v18, v6
  v_and_b32 v25, v18, v7
  v_and_b32 v26, v19, v6
  v_and_b32 v27, v19, v7
  v_add_f32 v4, v4, v10
  s_waitcnt vmcnt(12)
  v_mfma_f32_16x16x16_bf16 v[28:31], v[164:165], v[20:21], v[28:31]
  v_mfma_f32_16x16x16_bf16 v[32:35], v[166:167], v[20:21], v[32:35]
  buffer_load_dwordx4 v[68:71], v2, s[24:27], s52 offen offset:0 nt
  v_mfma_f32_16x16x16_bf16 v[28:31], v[168:169], v[22:23], v[28:31]
  v_mfma_f32_16x16x16_bf16 v[32:35], v[170:171], v[22:23], v[32:35]
  buffer_load_dwordx4 v[72:75], v2, s[24:27], s52 offen offset:256 nt
  v_mfma_f32_16x16x16_bf16 v[28:31], v[172:173], v[24:25], v[28:31]
  v_mfma_f32_16x16x16_bf16 v[32:35], v[174:175], v[24:25], v[32:35]
  buffer_load_dwordx4 v[76:79], v2, s[24:27], s52 offen offset:512 nt
  v_mfma_f32_16x16x16_bf16 v[28:31], v[176:177], v[26:27], v[28:31]
  v_mfma_f32_16x16x16_bf16 v[32:35], v[178:179], v[26:27], v[32:35]
  buffer_load_dwordx4 v[80:83], v2, s[24:27], s52 offen offset:768 nt
  s_add_u32 s66, s66, 1
  s_cmp_eq_u32 s66, s67
  s_cbranch_scc1 L_exit
  s_waitcnt vmcnt(12)
  v_mfma_f32_16x16x32_bf16 v[12:15], v[180:183], v[36:39], 0
  v_mfma_f32_16x16x32_bf16 v[12:15], v[184:187], v[40:43], v[12:15]
  v_mfma_f32_16x16x32_bf16 v[12:15], v[188:191], v[44:47], v[12:15]
  v_mfma_f32_16x16x32_bf16 v[12:15], v[192:195], v[48:51], v[12:15]
  s_cmp_ge_u32 s54, 38
  s_cbranch_scc1 L_dyn4
  s_add_u32 s52, s55, s53
  s_add_u32 s53, s53, 0x60000
  s_and_b32 s53, s53, 0xffffff
  s_add_u32 s54, s54, 1
  s_add_u32 s67, s67, 1
L_iss4:
  buffer_load_dwordx4 v[84:87], v1, s[20:23], s52 offen offset:0 nt
  buffer_load_dwordx4 v[88:91], v1, s[20:23], s52 offen offset:64 nt
  buffer_load_dwordx4 v[92:95], v1, s[20:23], s52 offen offset:128 nt
  buffer_load_dwordx4 v[96:99], v1, s[20:23], s52 offen offset:192 nt
  v_fma_f32 v16, v12, s57, v3
  v_fma_f32 v17, v13, s57, v3
  v_fma_f32 v18, v14, s57, v3
  v_fma_f32 v19, v15, s57, v3
  v_max3_f32 v8, v16, v17, v18
  v_max_f32 v8, v8, v19
  v_cmp_gt_f32 vcc, v8, v5
  s_cbranch_vccnz L_rare4
L_back4:
  v_exp_f32 v16, v16
  v_exp_f32 v17, v17
  v_exp_f32 v18, v18
  v_exp_f32 v19, v19
  v_add_f32 v9, v16, v17
  v_add_f32 v10, v18, v19
  v_cvt_pk_bf16_f32 v16, v16, v16
  v_cvt_pk_bf16_f32 v17, v17, v17
  v_cvt_pk_bf16_f32 v18, v18, v18
  v_cvt_pk_bf16_f32 v19, v19, v19
  v_add_f32 v4, v4, v9
  v_and_b32 v20, v16, v6
  v_and_b32 v21, v16, v7
  v_and_b32 v22, v17, v6
  v_and_b32 v23, v17, v7
  v_and_b32 v24, v18, v6
  v_and_b32 v25, v18, v7
  v_and_b32 v26, v19, v6
  v_and_b32 v27, v19, v7
  v_add_f32 v4, v4, v10
  s_waitcnt vmcnt(12)
  v_mfma_f32_16x16x16_bf16 v[28:31], v[196:197], v[20:21], v[28:31]
  v_mfma_f32_16x16x16_bf16 v[32:35], v[198:199], v[20:21], v[32:35]
  buffer_load_dwordx4 v[100:103], v2, s[24:27], s52 offen offset:0 nt
  v_mfma_f32_16x16x16_bf16 v[28:31], v[200:201], v[22:23], v[28:31]
  v_mfma_f32_16x16x16_bf16 v[32:35], v[202:203], v[22:23], v[32:35]
  buffer_load_dwordx4 v[104:107], v2, s[24:27], s52 offen offset:256 nt
  v_mfma_f32_16x16x16_bf16 v[28:31], v[204:205], v[24:25], v[28:31]
  v_mfma_f32_16x16x16_bf16 v[32:35], v[206:207], v[24:25], v[32:35]
  buffer_load_dwordx4 v[108:111], v2, s[24:27], s52 offen offset:512 nt
  v_mfma_f32_16x16x16_bf16 v[28:31], v[208:209], v[26:27], v[28:31]
  v_mfma_f32_16x16x16_bf16 v[32:35], v[210:211], v[26:27], v[32:35]
  buffer_load_dwordx4 v[112:115], v2, s[24:27], s52 offen offset:768 nt
  s_add_u32 s66, s66, 1
  s_cmp_lt_u32 s54, 32
  s_cbranch_scc1 L_loop
  s_cmp_ge_u32 s54, 37
  s_cbranch_scc1 L_loop
  s_atomic_add s65, s[70:71], 0 glc
  s_branch L_loop
L_exit:
  v_lshlrev_b32 v12, 4, v0
  s_lshl_b32 s58, s50, 11
  v_add_u32 v10, s58, v12
  ds_write_b128 v10, v[28:31] offset:2560
  ds_write_b128 v10, v[32:35] offset:3584
  v_mov_b32 v9, v4
  s_nop 1
  v_permlane32_swap_b32 v4, v9
  v_add_f32 v4, v4, v9
  v_mov_b32 v9, v4
  s_nop 1
  v_permlane16_swap_b32 v4, v9
  v_add_f32 v9, v4, v9
  v_sub_f32 v8, 0, v3
  v_bfe_u32 v13, v0, 2, 2
  v_lshlrev_b32 v11, 3, v13
  s_lshl_b32 s58, s50, 5
  v_add_u32 v11, s58, v11
  ds_write_b64 v11, v[8:9] offset:1024
  s_waitcnt lgkmcnt(0)
  s_barrier
  s_waitcnt vmcnt(0)
  v_lshrrev_b32 v10, 5, v0
  v_lshlrev_b32 v10, 12, v10
  v_bfe_u32 v11, v0, 4, 1
  v_lshl_add_u32 v10, v11, 15, v10
  v_and_b32 v11, 15, v0
  v_lshl_add_u32 v10, v11, 4, v10
  s_lshr_b32 s52, s2, 2
  s_lshl_b32 s52, s52, 16
  s_and_b32 s53, s2, 3
  s_lshl_b32 s53, s53, 13
  s_add_u32 s52, s52, s53
  s_lshl_b32 s53, s50, 8
  s_add_u32 s52, s52, s53
  buffer_load_dwordx4 v[52:55], v10, s[40:43], s52 offen offset:0 nt
  buffer_load_dwordx4 v[56:59], v10, s[40:43], s52 offen offset:1024 nt
  buffer_load_dwordx4 v[60:63], v10, s[40:43], s52 offen offset:2048 nt
  buffer_load_dwordx4 v[64:67], v10, s[40:43], s52 offen offset:3072 nt
  v_bfe_u32 v9, v0, 1, 1
  v_lshlrev_b32 v9, 4, v9
  v_mov_b32 v10, 0xffff
  v_lshlrev_b32 v9, v9, v10
  v_and_b32 v10, 1, v0
  v_lshlrev_b32 v10, 2, v10
  v_bfe_u32 v8, v0, 2, 2
  v_add_u32 v10, v10, v8
  v_cmp_eq_u32 vcc, 0, v10
  s_nop 1
  v_cndmask_b32 v16, 0, v9, vcc
  v_cmp_eq_u32 vcc, 1, v10
  s_nop 1
  v_cndmask_b32 v17, 0, v9, vcc
  v_cmp_eq_u32 vcc, 2, v10
  s_nop 1
  v_cndmask_b32 v18, 0, v9, vcc
  v_cmp_eq_u32 vcc, 3, v10
  s_nop 1
  v_cndmask_b32 v19, 0, v9, vcc
  v_and_b32 v9, 15, v0
  v_lshlrev_b32 v9, 2, v9
  v_lshrrev_b32 v10, 4, v0
  v_add_u32 v9, v9, v10
  v_lshlrev_b32 v8, 4, v9
  s_lshl_b32 s55, s2, 12
  s_lshl_b32 s56, s50, 10
  s_add_u32 s55, s55, s56
  s_add_u32 s55, s55, 2097152
  s_barrier
  ds_read_b128 v[20:23], v12 offset:10752
  s_waitcnt lgkmcnt(0)
  v_and_b32 v36, v20, v16
  v_and_b32 v37, v20, v17
  v_and_b32 v38, v20, v18
  v_and_b32 v39, v20, v19
  v_and_b32 v40, v21, v16
  v_and_b32 v41, v21, v17
  v_and_b32 v42, v21, v18
  v_and_b32 v43, v21, v19
  v_and_b32 v44, v22, v16
  v_and_b32 v45, v22, v17
  v_and_b32 v46, v22, v18
  v_and_b32 v47, v22, v19
  v_and_b32 v48, v23, v16
  v_and_b32 v49, v23, v17
  v_and_b32 v50, v23, v18
  v_and_b32 v51, v23, v19
  s_waitcnt vmcnt(0)
  v_mfma_f32_16x16x32_bf16 v[24:27], v[36:39], v[52:55], 0
  v_mfma_f32_16x16x32_bf16 v[24:27], v[40:43], v[56:59], v[24:27]
  v_mfma_f32_16x16x32_bf16 v[24:27], v[44:47], v[60:63], v[24:27]
  v_mfma_f32_16x16x32_bf16 v[24:27], v[48:51], v[64:67], v[24:27]
  s_nop 7
  v_mov_b32 v25, s51
  v_mov_b32 v27, s51
  buffer_store_dwordx4 v[24:27], v8, s[28:31], s55 offen sc1
  s_endpgm
L_rare0:
  v_mov_b32 v9, v8
  s_nop 1
  v_permlane32_swap_b32 v8, v9
  v_max_f32 v8, v8, v9
  v_mov_b32 v9, v8
  s_nop 1
  v_permlane16_swap_b32 v8, v9
  v_max_f32 v8, v8, v9
  v_max_f32 v8, v8, v5
  v_max_f32 v9, 0, v8
  v_exp_f32_e64 v9, -v9
  v_sub_f32 v16, v16, v8
  v_sub_f32 v17, v17, v8
  v_sub_f32 v18, v18, v8
  v_sub_f32 v19, v19, v8
  v_sub_f32 v3, v3, v8
  v_mov_b32 v5, 0
  v_mul_f32 v28, v28, v9
  v_mul_f32 v29, v29, v9
  v_mul_f32 v30, v30, v9
  v_mul_f32 v31, v31, v9
  v_mul_f32 v32, v32, v9
  v_mul_f32 v33, v33, v9
  v_mul_f32 v34, v34, v9
  v_mul_f32 v35, v35, v9
  v_mul_f32 v4, v4, v9
  s_branch L_back0
L_dyn0:
  s_cmp_lg_u32 s69, 0
  s_cbranch_scc1 L_have0
  s_waitcnt lgkmcnt(0)
  s_min_u32 s58, s65, 4096
  s_mov_b32 s69, s93
  s_mul_i32 s92, s58, 12288
  s_add_u32 s92, s92, s68
  s_sub_u32 s92, s92, 294912
  s_cmp_ge_u32 s58, 24
  s_cbranch_scc1 L_dynm0
  s_lshr_b32 s92, s58, 3
  s_mul_i32 s92, s92, 96
  s_and_b32 s59, s58, 7
  s_mul_i32 s59, s59, 3
  s_add_u32 s92, s92, s59
  s_add_u32 s92, s92, s50
  s_lshl_b32 s92, s92, 12
L_dynm0:
  s_cmp_lt_u32 s92, 0x1000000
  s_cbranch_scc0 L_dry0
  s_cmp_lt_u32 s58, 85
  s_cselect_b32 s93, 1, 1
  s_mov_b32 s65, s93
  s_atomic_add s65, s[70:71], 0 glc
L_have0:
  s_cmp_lt_u32 s92, 0x1000000
  s_cbranch_scc0 L_dry0
  s_sub_u32 s69, s69, 1
  s_add_u32 s67, s67, 1
  s_add_u32 s58, s92, s56
  s_and_b32 s58, s58, 0xffffff
  s_add_u32 s52, s58, s55
  s_add_u32 s92, s92, 12288
  s_branch L_iss0
L_dry0:
  s_mov_b32 s69, 1
  s_mov_b32 s22, 0
  s_mov_b32 s26, 0
  s_branch L_iss0
L_rare1:
  v_mov_b32 v9, v8
  s_nop 1
  v_permlane32_swap_b32 v8, v9
  v_max_f32 v8, v8, v9
  v_mov_b32 v9, v8
  s_nop 1
  v_permlane16_swap_b32 v8, v9
  v_max_f32 v8, v8, v9
  v_max_f32 v8, v8, v5
  v_max_f32 v9, 0, v8
  v_exp_f32_e64 v9, -v9
  v_sub_f32 v16, v16, v8
  v_sub_f32 v17, v17, v8
  v_sub_f32 v18, v18, v8
  v_sub_f32 v19, v19, v8
  v_sub_f32 v3, v3, v8
  v_mov_b32 v5, 0
  v_mul_f32 v28, v28, v9
  v_mul_f32 v29, v29, v9
  v_mul_f32 v30, v30, v9
  v_mul_f32 v31, v31, v9
  v_mul_f32 v32, v32, v9
  v_mul_f32 v33, v33, v9
  v_mul_f32 v34, v34, v9
  v_mul_f32 v35, v35, v9
  v_mul_f32 v4, v4, v9
  s_branch L_back1
L_dyn1:
  s_cmp_lg_u32 s69, 0
  s_cbranch_scc1 L_have1
  s_waitcnt lgkmcnt(0)
  s_min_u32 s58, s65, 4096
  s_mov_b32 s69, s93
  s_mul_i32 s92, s58, 12288
  s_add_u32 s92, s92, s68
  s_sub_u32 s92, s92, 294912
  s_cmp_ge_u32 s58, 24
  s_cbranch_scc1 L_dynm1
  s_lshr_b32 s92, s58, 3
  s_mul_i32 s92, s92, 96
  s_and_b32 s59, s58, 7
  s_mul_i32 s59, s59, 3
  s_add_u32 s92, s92, s59
  s_add_u32 s92, s92, s50
  s_lshl_b32 s92, s92, 12
L_dynm1:
  s_cmp_lt_u32 s92, 0x1000000
  s_cbranch_scc0 L_dry1
  s_cmp_lt_u32 s58, 85
  s_cselect_b32 s93, 1, 1
  s_mov_b32 s65, s93
  s_atomic_add s65, s[70:71], 0 glc
L_have1:
  s_cmp_lt_u32 s92, 0x1000000
  s_cbranch_scc0 L_dry1
  s_sub_u32 s69, s69, 1
  s_add_u32 s67, s67, 1
  s_add_u32 s58, s92, s56
  s_and_b32 s58, s58, 0xffffff
  s_add_u32 s52, s58, s55
  s_add_u32 s92, s92, 12288
  s_branch L_iss1
L_dry1:
  s_mov_b32 s69, 1
  s_mov_b32 s22, 0
  s_mov_b32 s26, 0
  s_branch L_iss1
L_rare2:
  v_mov_b32 v9, v8
  s_nop 1
  v_permlane32_swap_b32 v8, v9
  v_max_f32 v8, v8, v9
  v_mov_b32 v9, v8
  s_nop 1
  v_permlane16_swap_b32 v8, v9
  v_max_f32 v8, v8, v9
  v_max_f32 v8, v8, v5
  v_max_f32 v9, 0, v8
  v_exp_f32_e64 v9, -v9
  v_sub_f32 v16, v16, v8
  v_sub_f32 v17, v17, v8
  v_sub_f32 v18, v18, v8
  v_sub_f32 v19, v19, v8
  v_sub_f32 v3, v3, v8
  v_mov_b32 v5, 0
  v_mul_f32 v28, v28, v9
  v_mul_f32 v29, v29, v9
  v_mul_f32 v30, v30, v9
  v_mul_f32 v31, v31, v9
  v_mul_f32 v32, v32, v9
  v_mul_f32 v33, v33, v9
  v_mul_f32 v34, v34, v9
  v_mul_f32 v35, v35, v9
  v_mul_f32 v4, v4, v9
  s_branch L_back2
L_dyn2:
  s_cmp_lg_u32 s69, 0
  s_cbranch_scc1 L_have2
  s_waitcnt lgkmcnt(0)
  s_min_u32 s58, s65, 4096
  s_mov_b32 s69, s93
  s_mul_i32 s92, s58, 12288
  s_add_u32 s92, s92, s68
  s_sub_u32 s92, s92, 294912
  s_cmp_ge_u32 s58, 24
  s_cbranch_scc1 L_dynm2
  s_lshr_b32 s92, s58, 3
  s_mul_i32 s92, s92, 96
  s_and_b32 s59, s58, 7
  s_mul_i32 s59, s59, 3
  s_add_u32 s92, s92, s59
  s_add_u32 s92, s92, s50
  s_lshl_b32 s92, s92, 12
L_dynm2:
  s_cmp_lt_u32 s92, 0x1000000
  s_cbranch_scc0 L_dry2
  s_cmp_lt_u32 s58, 85
  s_cselect_b32 s93, 1, 1
  s_mov_b32 s65, s93
  s_atomic_add s65, s[70:71], 0 glc
L_have2:
  s_cmp_lt_u32 s92, 0x1000000
  s_cbranch_scc0 L_dry2
  s_sub_u32 s69, s69, 1
  s_add_u32 s67, s67, 1
  s_add_u32 s58, s92, s56
  s_and_b32 s58, s58, 0xffffff
  s_add_u32 s52, s58, s55
  s_add_u32 s92, s92, 12288
  s_branch L_iss2
L_dry2:
  s_mov_b32 s69, 1
  s_mov_b32 s22, 0
  s_mov_b32 s26, 0
  s_branch L_iss2
L_rare3:
  v_mov_b32 v9, v8
  s_nop 1
  v_permlane32_swap_b32 v8, v9
  v_max_f32 v8, v8, v9
  v_mov_b32 v9, v8
  s_nop 1
  v_permlane16_swap_b32 v8, v9
  v_max_f32 v8, v8, v9
  v_max_f32 v8, v8, v5
  v_max_f32 v9, 0, v8
  v_exp_f32_e64 v9, -v9
  v_sub_f32 v16, v16, v8
  v_sub_f32 v17, v17, v8
  v_sub_f32 v18, v18, v8
  v_sub_f32 v19, v19, v8
  v_sub_f32 v3, v3, v8
  v_mov_b32 v5, 0
  v_mul_f32 v28, v28, v9
  v_mul_f32 v29, v29, v9
  v_mul_f32 v30, v30, v9
  v_mul_f32 v31, v31, v9
  v_mul_f32 v32, v32, v9
  v_mul_f32 v33, v33, v9
  v_mul_f32 v34, v34, v9
  v_mul_f32 v35, v35, v9
  v_mul_f32 v4, v4, v9
  s_branch L_back3
L_dyn3:
  s_cmp_lg_u32 s69, 0
  s_cbranch_scc1 L_have3
  s_waitcnt lgkmcnt(0)
  s_min_u32 s58, s65, 4096
  s_mov_b32 s69, s93
  s_mul_i32 s92, s58, 12288
  s_add_u32 s92, s92, s68
  s_sub_u32 s92, s92, 294912
  s_cmp_ge_u32 s58, 24
  s_cbranch_scc1 L_dynm3
  s_lshr_b32 s92, s58, 3
  s_mul_i32 s92, s92, 96
  s_and_b32 s59, s58, 7
  s_mul_i32 s59, s59, 3
  s_add_u32 s92, s92, s59
  s_add_u32 s92, s92, s50
  s_lshl_b32 s92, s92, 12
L_dynm3:
  s_cmp_lt_u32 s92, 0x1000000
  s_cbranch_scc0 L_dry3
  s_cmp_lt_u32 s58, 85
  s_cselect_b32 s93, 1, 1
  s_mov_b32 s65, s93
  s_atomic_add s65, s[70:71], 0 glc
L_have3:
  s_cmp_lt_u32 s92, 0x1000000
  s_cbranch_scc0 L_dry3
  s_sub_u32 s69, s69, 1
  s_add_u32 s67, s67, 1
  s_add_u32 s58, s92, s56
  s_and_b32 s58, s58, 0xffffff
  s_add_u32 s52, s58, s55
  s_add_u32 s92, s92, 12288
  s_branch L_iss3
L_dry3:
  s_mov_b32 s69, 1
  s_mov_b32 s22, 0
  s_mov_b32 s26, 0
  s_branch L_iss3
L_rare4:
  v_mov_b32 v9, v8
  s_nop 1
  v_permlane32_swap_b32 v8, v9
  v_max_f32 v8, v8, v9
  v_mov_b32 v9, v8
  s_nop 1
  v_permlane16_swap_b32 v8, v9
  v_max_f32 v8, v8, v9
  v_max_f32 v8, v8, v5
  v_max_f32 v9, 0, v8
  v_exp_f32_e64 v9, -v9
  v_sub_f32 v16, v16, v8
  v_sub_f32 v17, v17, v8
  v_sub_f32 v18, v18, v8
  v_sub_f32 v19, v19, v8
  v_sub_f32 v3, v3, v8
  v_mov_b32 v5, 0
  v_mul_f32 v28, v28, v9
  v_mul_f32 v29, v29, v9
  v_mul_f32 v30, v30, v9
  v_mul_f32 v31, v31, v9
  v_mul_f32 v32, v32, v9
  v_mul_f32 v33, v33, v9
  v_mul_f32 v34, v34, v9
  v_mul_f32 v35, v35, v9
  v_mul_f32 v4, v4, v9
  s_branch L_back4
L_dyn4:
  s_cmp_lg_u32 s69, 0
  s_cbranch_scc1 L_have4
  s_waitcnt lgkmcnt(0)
  s_min_u32 s58, s65, 4096
  s_mov_b32 s69, s93
  s_mul_i32 s92, s58, 12288
  s_add_u32 s92, s92, s68
  s_sub_u32 s92, s92, 294912
  s_cmp_ge_u32 s58, 24
  s_cbranch_scc1 L_dynm4
  s_lshr_b32 s92, s58, 3
  s_mul_i32 s92, s92, 96
  s_and_b32 s59, s58, 7
  s_mul_i32 s59, s59, 3
  s_add_u32 s92, s92, s59
  s_add_u32 s92, s92, s50
  s_lshl_b32 s92, s92, 12
L_dynm4:
  s_cmp_lt_u32 s92, 0x1000000
  s_cbranch_scc0 L_dry4
  s_cmp_lt_u32 s58, 85
  s_cselect_b32 s93, 1, 1
  s_mov_b32 s65, s93
  s_atomic_add s65, s[70:71], 0 glc
L_have4:
  s_cmp_lt_u32 s92, 0x1000000
  s_cbranch_scc0 L_dry4
  s_sub_u32 s69, s69, 1
  s_add_u32 s67, s67, 1
  s_add_u32 s58, s92, s56
  s_and_b32 s58, s58, 0xffffff
  s_add_u32 s52, s58, s55
  s_add_u32 s92, s92, 12288
  s_branch L_iss4
L_dry4:
  s_mov_b32 s69, 1
  s_mov_b32 s22, 0
  s_mov_b32 s26, 0
  s_branch L_iss4
L_p1rare0:
  v_mov_b32 v9, v8
  s_nop 1
  v_permlane32_swap_b32 v8, v9
  v_max_f32 v8, v8, v9
  v_mov_b32 v9, v8
  s_nop 1
  v_permlane16_swap_b32 v8, v9
  v_max_f32 v8, v8, v9
  v_max_f32 v8, v8, v5
  v_max_f32 v9, 0, v8
  v_exp_f32_e64 v9, -v9
  v_sub_f32 v16, v16, v8
  v_sub_f32 v17, v17, v8
  v_sub_f32 v18, v18, v8
  v_sub_f32 v19, v19, v8
  v_sub_f32 v3, v3, v8
  v_mov_b32 v5, 0
  v_mul_f32 v28, v28, v9
  v_mul_f32 v29, v29, v9
  v_mul_f32 v30, v30, v9
  v_mul_f32 v31, v31, v9
  v_mul_f32 v32, v32, v9
  v_mul_f32 v33, v33, v9
  v_mul_f32 v34, v34, v9
  v_mul_f32 v35, v35, v9
  v_mul_f32 v4, v4, v9
  s_branch L_p1back0
L_p1rare1:
  v_mov_b32 v9, v8
  s_nop 1
  v_permlane32_swap_b32 v8, v9
  v_max_f32 v8, v8, v9
  v_mov_b32 v9, v8
  s_nop 1
  v_permlane16_swap_b32 v8, v9
  v_max_f32 v8, v8, v9
  v_max_f32 v8, v8, v5
  v_max_f32 v9, 0, v8
  v_exp_f32_e64 v9, -v9
  v_sub_f32 v16, v16, v8
  v_sub_f32 v17, v17, v8
  v_sub_f32 v18, v18, v8
  v_sub_f32 v19, v19, v8
  v_sub_f32 v3, v3, v8
  v_mov_b32 v5, 0
  v_mul_f32 v28, v28, v9
  v_mul_f32 v29, v29, v9
  v_mul_f32 v30, v30, v9
  v_mul_f32 v31, v31, v9
  v_mul_f32 v32, v32, v9
  v_mul_f32 v33, v33, v9
  v_mul_f32 v34, v34, v9
  v_mul_f32 v35, v35, v9
  v_mul_f32 v4, v4, v9
  s_branch L_p1back1
L_p1rare2:
  v_mov_b32 v9, v8
  s_nop 1
  v_permlane32_swap_b32 v8, v9
  v_max_f32 v8, v8, v9
  v_mov_b32 v9, v8
  s_nop 1
  v_permlane16_swap_b32 v8, v9
  v_max_f32 v8, v8, v9
  v_max_f32 v8, v8, v5
  v_max_f32 v9, 0, v8
  v_exp_f32_e64 v9, -v9
  v_sub_f32 v16, v16, v8
  v_sub_f32 v17, v17, v8
  v_sub_f32 v18, v18, v8
  v_sub_f32 v19, v19, v8
  v_sub_f32 v3, v3, v8
  v_mov_b32 v5, 0
  v_mul_f32 v28, v28, v9
  v_mul_f32 v29, v29, v9
  v_mul_f32 v30, v30, v9
  v_mul_f32 v31, v31, v9
  v_mul_f32 v32, v32, v9
  v_mul_f32 v33, v33, v9
  v_mul_f32 v34, v34, v9
  v_mul_f32 v35, v35, v9
  v_mul_f32 v4, v4, v9
  s_branch L_p1back2
L_p1rare3:
  v_mov_b32 v9, v8
  s_nop 1
  v_permlane32_swap_b32 v8, v9
  v_max_f32 v8, v8, v9
  v_mov_b32 v9, v8
  s_nop 1
  v_permlane16_swap_b32 v8, v9
  v_max_f32 v8, v8, v9
  v_max_f32 v8, v8, v5
  v_max_f32 v9, 0, v8
  v_exp_f32_e64 v9, -v9
  v_sub_f32 v16, v16, v8
  v_sub_f32 v17, v17, v8
  v_sub_f32 v18, v18, v8
  v_sub_f32 v19, v19, v8
  v_sub_f32 v3, v3, v8
  v_mov_b32 v5, 0
  v_mul_f32 v28, v28, v9
  v_mul_f32 v29, v29, v9
  v_mul_f32 v30, v30, v9
  v_mul_f32 v31, v31, v9
  v_mul_f32 v32, v32, v9
  v_mul_f32 v33, v33, v9
  v_mul_f32 v34, v34, v9
  v_mul_f32 v35, v35, v9
  v_mul_f32 v4, v4, v9
  s_branch L_p1back3
L_p1rare4:
  v_mov_b32 v9, v8
  s_nop 1
  v_permlane32_swap_b32 v8, v9
  v_max_f32 v8, v8, v9
  v_mov_b32 v9, v8
  s_nop 1
  v_permlane16_swap_b32 v8, v9
  v_max_f32 v8, v8, v9
  v_max_f32 v8, v8, v5
  v_max_f32 v9, 0, v8
  v_exp_f32_e64 v9, -v9
  v_sub_f32 v16, v16, v8
  v_sub_f32 v17, v17, v8
  v_sub_f32 v18, v18, v8
  v_sub_f32 v19, v19, v8
  v_sub_f32 v3, v3, v8
  v_mov_b32 v5, 0
  v_mul_f32 v28, v28, v9
  v_mul_f32 v29, v29, v9
  v_mul_f32 v30, v30, v9
  v_mul_f32 v31, v31, v9
  v_mul_f32 v32, v32, v9
  v_mul_f32 v33, v33, v9
  v_mul_f32 v34, v34, v9
  v_mul_f32 v35, v35, v9
  v_mul_f32 v4, v4, v9
  s_branch L_p1back4
L_qs:
  s_mov_b32 s54, 3
  s_add_u32 s53, s53, 0x120000
  s_and_b32 s53, s53, 0xffffff
  v_lshrrev_b32 v13, 3, v0
  v_lshlrev_b32 v14, 5, v13
  s_lshl_b32 s59, s50, 8
  v_lshlrev_b32 v13, 17, v13
  v_and_b32 v15, 7, v0
  v_lshl_add_u32 v13, v15, 4, v13
  s_lshl_b32 s58, s50, 20
  s_lshl_b32 s60, s48, 10
  s_add_u32 s58, s58, s60
  s_lshl_b32 s60, s49, 7
  s_add_u32 s58, s58, s60
  s_waitcnt lgkmcnt(0)
  s_mov_b64 s[32:33], s[4:5]
  s_mov_b64 s[36:37], s[10:11]
  buffer_load_dwordx4 v[36:39], v14, s[32:35], s59 offen
  buffer_load_dwordx4 v[40:43], v14, s[32:35], s59 offen offset:16
  buffer_load_dwordx4 v[148:151], v13, s[36:39], s58 offen nt
  s_add_u32 s58, s58, 8192
  buffer_load_dwordx4 v[152:155], v13, s[36:39], s58 offen nt
  s_add_u32 s58, s58, 8192
  buffer_load_dwordx4 v[156:159], v13, s[36:39], s58 offen nt
  s_add_u32 s58, s58, 8192
  buffer_load_dwordx4 v[160:163], v13, s[36:39], s58 offen nt
  s_add_u32 s58, s58, 8192
  buffer_load_dwordx4 v[164:167], v13, s[36:39], s58 offen nt
  s_add_u32 s58, s58, 8192
  buffer_load_dwordx4 v[168:171], v13, s[36:39], s58 offen nt
  s_add_u32 s58, s58, 8192
  buffer_load_dwordx4 v[172:175], v13, s[36:39], s58 offen nt
  s_add_u32 s58, s58, 8192
  buffer_load_dwordx4 v[176:179], v13, s[36:39], s58 offen nt
  s_add_u32 s58, s58, 8192
  buffer_load_dwordx4 v[180:183], v13, s[36:39], s58 offen nt
  s_add_u32 s58, s58, 8192
  buffer_load_dwordx4 v[184:187], v13, s[36:39], s58 offen nt
  s_add_u32 s58, s58, 8192
  buffer_load_dwordx4 v[188:191], v13, s[36:39], s58 offen nt
  s_add_u32 s58, s58, 8192
  buffer_load_dwordx4 v[192:195], v13, s[36:39], s58 offen nt
  s_add_u32 s58, s58, 8192
  buffer_load_dwordx4 v[196:199], v13, s[36:39], s58 offen nt
  s_add_u32 s58, s58, 8192
  buffer_load_dwordx4 v[200:203], v13, s[36:39], s58 offen nt
  s_add_u32 s58, s58, 8192
  buffer_load_dwordx4 v[204:207], v13, s[36:39], s58 offen nt
  s_add_u32 s58, s58, 8192
  buffer_load_dwordx4 v[208:211], v13, s[36:39], s58 offen nt
  s_mov_b64 s[20:21], s[6:7]
  s_mov_b64 s[24:25], s[8:9]
  v_mov_b32 v44, 0
  v_mov_b32 v45, 0
  v_mov_b32 v46, 0
  v_mov_b32 v47, 0
  v_mov_b32 v48, 0
  v_mov_b32 v49, 0
  v_mov_b32 v50, 0
  v_mov_b32 v51, 0
  v_lshlrev_b32 v15, 5, v15
  v_lshrrev_b32 v16, 4, v0
  v_lshl_add_u32 v15, v16, 3, v15
  v_add_u32 v15, s59, v15
  s_waitcnt vmcnt(16)
  v_and_b32 v20, 0xffff, v36
  v_lshlrev_b32 v21, 16, v36
  v_lshrrev_b32 v22, 16, v36
  v_and_b32 v23, 0xffff0000, v36
  v_and_b32 v24, 0xffff, v37
  v_lshlrev_b32 v25, 16, v37
  s_waitcnt vmcnt(15)
  v_dot2_f32_bf16 v44, v148, v20, v44
  v_dot2_f32_bf16 v45, v148, v21, v45
  v_dot2_f32_bf16 v46, v149, v20, v46
  v_dot2_f32_bf16 v47, v149, v21, v47
  v_dot2_f32_bf16 v48, v150, v20, v48
  v_dot2_f32_bf16 v49, v150, v21, v49
  v_dot2_f32_bf16 v50, v151, v20, v50
  v_dot2_f32_bf16 v51, v151, v21, v51
  v_lshrrev_b32 v26, 16, v37
  v_and_b32 v27, 0xffff0000, v37
  s_waitcnt vmcnt(14)
  v_dot2_f32_bf16 v44, v152, v22, v44
  v_dot2_f32_bf16 v45, v152, v23, v45
  v_dot2_f32_bf16 v46, v153, v22, v46
  v_dot2_f32_bf16 v47, v153, v23, v47
  v_dot2_f32_bf16 v48, v154, v22, v48
  v_dot2_f32_bf16 v49, v154, v23, v49
  v_dot2_f32_bf16 v50, v155, v22, v50
  v_dot2_f32_bf16 v51, v155, v23, v51
  v_and_b32 v20, 0xffff, v38
  v_lshlrev_b32 v21, 16, v38
  s_waitcnt vmcnt(13)
  v_dot2_f32_bf16 v44, v156, v24, v44
  v_dot2_f32_bf16 v45, v156, v25, v45
  v_dot2_f32_bf16 v46, v157, v24, v46
  v_dot2_f32_bf16 v47, v157, v25, v47
  v_dot2_f32_bf16 v48, v158, v24, v48
  v_dot2_f32_bf16 v49, v158, v25, v49
  v_dot2_f32_bf16 v50, v159, v24, v50
  v_dot2_f32_bf16 v51, v159, v25, v51
  v_lshrrev_b32 v22, 16, v38
  v_and_b32 v23, 0xffff0000, v38
  s_waitcnt vmcnt(12)
  v_dot2_f32_bf16 v44, v160, v26, v44
  v_dot2_f32_bf16 v45, v160, v27, v45
  v_dot2_f32_bf16 v46, v161, v26, v46
  v_dot2_f32_bf16 v47, v161, v27, v47
  v_dot2_f32_bf16 v48, v162, v26, v48
  v_dot2_f32_bf16 v49, v162, v27, v49
  v_dot2_f32_bf16 v50, v163, v26, v50
  v_dot2_f32_bf16 v51, v163, v27, v51
  v_and_b32 v24, 0xffff, v39
  v_lshlrev_b32 v25, 16, v39
  s_waitcnt vmcnt(11)
  v_dot2_f32_bf16 v44, v164, v20, v44
  v_dot2_f32_bf16 v45, v164, v21, v45
  v_dot2_f32_bf16 v46, v165, v20, v46
  v_dot2_f32_bf16 v47, v165, v21, v47
  v_dot2_f32_bf16 v48, v166, v20, v48
  v_dot2_f32_bf16 v49, v166, v21, v49
  v_dot2_f32_bf16 v50, v167, v20, v50
  v_dot2_f32_bf16 v51, v167, v21, v51
  v_lshrrev_b32 v26, 16, v39
  v_and_b32 v27, 0xffff0000, v39
  s_waitcnt vmcnt(10)
  v_dot2_f32_bf16 v44, v168, v22, v44
  v_dot2_f32_bf16 v45, v168, v23, v45
  v_dot2_f32_bf16 v46, v169, v22, v46
  v_dot2_f32_bf16 v47, v169, v23, v47
  v_dot2_f32_bf16 v48, v170, v22, v48
  v_dot2_f32_bf16 v49, v170, v23, v49
  v_dot2_f32_bf16 v50, v171, v22, v50
  v_dot2_f32_bf16 v51, v171, v23, v51
  v_and_b32 v20, 0xffff, v40
  v_lshlrev_b32 v21, 16, v40
  s_waitcnt vmcnt(9)
  v_dot2_f32_bf16 v44, v172, v24, v44
  v_dot2_f32_bf16 v45, v172, v25, v45
  v_dot2_f32_bf16 v46, v173, v24, v46
  v_dot2_f32_bf16 v47, v173, v25, v47
  v_dot2_f32_bf16 v48, v174, v24, v48
  v_dot2_f32_bf16 v49, v174, v25, v49
  v_dot2_f32_bf16 v50, v175, v24, v50
  v_dot2_f32_bf16 v51, v175, v25, v51
  v_lshrrev_b32 v22, 16, v40
  v_and_b32 v23, 0xffff0000, v40
  s_waitcnt vmcnt(8)
  v_dot2_f32_bf16 v44, v176, v26, v44
  v_dot2_f32_bf16 v45, v176, v27, v45
  v_dot2_f32_bf16 v46, v177, v26, v46
  v_dot2_f32_bf16 v47, v177, v27, v47
  v_dot2_f32_bf16 v48, v178, v26, v48
  v_dot2_f32_bf16 v49, v178, v27, v49
  v_dot2_f32_bf16 v50, v179, v26, v50
  v_dot2_f32_bf16 v51, v179, v27, v51
  v_and_b32 v24, 0xffff, v41
  v_lshlrev_b32 v25, 16, v41
  s_waitcnt vmcnt(7)
  v_dot2_f32_bf16 v44, v180, v20, v44
  v_dot2_f32_bf16 v45, v180, v21, v45
  v_dot2_f32_bf16 v46, v181, v20, v46
  v_dot2_f32_bf16 v47, v181, v21, v47
  v_dot2_f32_bf16 v48, v182, v20, v48
  v_dot2_f32_bf16 v49, v182, v21, v49
  v_dot2_f32_bf16 v50, v183, v20, v50
  v_dot2_f32_bf16 v51, v183, v21, v51
  v_lshrrev_b32 v26, 16, v41
  v_and_b32 v27, 0xffff0000, v41
  s_waitcnt vmcnt(6)
  v_dot2_f32_bf16 v44, v184, v22, v44
  v_dot2_f32_bf16 v45, v184, v23, v45
  v_dot2_f32_bf16 v46, v185, v22, v46
  v_dot2_f32_bf16 v47, v185, v23, v47
  v_dot2_f32_bf16 v48, v186, v22, v48
  v_dot2_f32_bf16 v49, v186, v23, v49
  v_dot2_f32_bf16 v50, v187, v22, v50
  v_dot2_f32_bf16 v51, v187, v23, v51
  v_and_b32 v20, 0xffff, v42
  v_lshlrev_b32 v21, 16, v42
  s_waitcnt vmcnt(5)
  v_dot2_f32_bf16 v44, v188, v24, v44
  v_dot2_f32_bf16 v45, v188, v25, v45
  v_dot2_f32_bf16 v46, v189, v24, v46
  v_dot2_f32_bf16 v47, v189, v25, v47
  v_dot2_f32_bf16 v48, v190, v24, v48
  v_dot2_f32_bf16 v49, v190, v25, v49
  v_dot2_f32_bf16 v50, v191, v24, v50
  v_dot2_f32_bf16 v51, v191, v25, v51
  v_lshrrev_b32 v22, 16, v42
  v_and_b32 v23, 0xffff0000, v42
  s_waitcnt vmcnt(4)
  v_dot2_f32_bf16 v44, v192, v26, v44
  v_dot2_f32_bf16 v45, v192, v27, v45
  v_dot2_f32_bf16 v46, v193, v26, v46
  v_dot2_f32_bf16 v47, v193, v27, v47
  v_dot2_f32_bf16 v48, v194, v26, v48
  v_dot2_f32_bf16 v49, v194, v27, v49
  v_dot2_f32_bf16 v50, v195, v26, v50
  v_dot2_f32_bf16 v51, v195, v27, v51
  v_and_b32 v24, 0xffff, v43
  v_lshlrev_b32 v25, 16, v43
  s_waitcnt vmcnt(3)
  v_dot2_f32_bf16 v44, v196, v20, v44
  v_dot2_f32_bf16 v45, v196, v21, v45
  v_dot2_f32_bf16 v46, v197, v20, v46
  v_dot2_f32_bf16 v47, v197, v21, v47
  v_dot2_f32_bf16 v48, v198, v20, v48
  v_dot2_f32_bf16 v49, v198, v21, v49
  v_dot2_f32_bf16 v50, v199, v20, v50
  v_dot2_f32_bf16 v51, v199, v21, v51
  v_lshrrev_b32 v26, 16, v43
  v_and_b32 v27, 0xffff0000, v43
  s_waitcnt vmcnt(2)
  v_dot2_f32_bf16 v44, v200, v22, v44
  v_dot2_f32_bf16 v45, v200, v23, v45
  v_dot2_f32_bf16 v46, v201, v22, v46
  v_dot2_f32_bf16 v47, v201, v23, v47
  v_dot2_f32_bf16 v48, v202, v22, v48
  v_dot2_f32_bf16 v49, v202, v23, v49
  v_dot2_f32_bf16 v50, v203, v22, v50
  v_dot2_f32_bf16 v51, v203, v23, v51
  s_waitcnt vmcnt(1)
  v_dot2_f32_bf16 v44, v204, v24, v44
  v_dot2_f32_bf16 v45, v204, v25, v45
  v_dot2_f32_bf16 v46, v205, v24, v46
  v_dot2_f32_bf16 v47, v205, v25, v47
  v_dot2_f32_bf16 v48, v206, v24, v48
  v_dot2_f32_bf16 v49, v206, v25, v49
  v_dot2_f32_bf16 v50, v207, v24, v50
  v_dot2_f32_bf16 v51, v207, v25, v51
  s_waitcnt vmcnt(0)
  v_dot2_f32_bf16 v44, v208, v26, v44
  v_dot2_f32_bf16 v45, v208, v27, v45
  v_dot2_f32_bf16 v46, v209, v26, v46
  v_dot2_f32_bf16 v47, v209, v27, v47
  v_dot2_f32_bf16 v48, v210, v26, v48
  v_dot2_f32_bf16 v49, v210, v27, v49
  v_dot2_f32_bf16 v50, v211, v26, v50
  v_dot2_f32_bf16 v51, v211, v27, v51
  v_permlane32_swap_b32 v44, v48
  s_nop 0
  v_permlane32_swap_b32 v46, v50
  v_permlane32_swap_b32 v45, v49
  v_permlane32_swap_b32 v47, v51
  v_add_f32 v44, v44, v48
  v_add_f32 v46, v46, v50
  v_add_f32 v45, v45, v49
  v_add_f32 v47, v47, v51
  v_permlane16_swap_b32 v44, v46
  s_nop 0
  v_permlane16_swap_b32 v45, v47
  v_add_f32 v44, v44, v46
  v_add_f32 v45, v45, v47
  s_nop 0
  v_add_f32_dpp v44, v44, v44 row_ror:8 row_mask:0xf bank_mask:0xf
  v_add_f32_dpp v45, v45, v45 row_ror:8 row_mask:0xf bank_mask:0xf
  ds_write_b64 v15, v[44:45] offset:1280
  s_waitcnt lgkmcnt(0)
  s_barrier
  s_barrier
  s_branch L_join
L_pre:
  s_setprio 3
  s_cmp_lt_u32 s49, 8
  s_cbranch_scc1 L_pre3
  s_waitcnt lgkmcnt(0)
  s_mov_b64 s[28:29], s[18:19]
  s_mov_b64 s[40:41], s[12:13]
  s_mov_b64 s[44:45], s[14:15]
  s_load_dword s51, s[18:19], 0
  s_branch L_svc
L_pre3:
  v_lshrrev_b32 v13, 3, v0
  v_lshlrev_b32 v14, 5, v13
  s_lshl_b32 s59, s50, 8
  v_lshlrev_b32 v13, 17, v13
  v_and_b32 v15, 7, v0
  v_lshl_add_u32 v13, v15, 4, v13
  s_lshl_b32 s58, s50, 20
  s_lshl_b32 s60, s48, 10
  s_add_u32 s58, s58, s60
  s_lshl_b32 s60, s49, 7
  s_add_u32 s58, s58, s60
  s_waitcnt lgkmcnt(0)
  s_mov_b64 s[32:33], s[4:5]
  s_mov_b64 s[36:37], s[10:11]
  buffer_load_dwordx4 v[36:39], v14, s[32:35], s59 offen
  buffer_load_dwordx4 v[40:43], v14, s[32:35], s59 offen offset:16
  buffer_load_dwordx4 v[148:151], v13, s[36:39], s58 offen nt
  s_add_u32 s58, s58, 8192
  buffer_load_dwordx4 v[152:155], v13, s[36:39], s58 offen nt
  s_add_u32 s58, s58, 8192
  buffer_load_dwordx4 v[156:159], v13, s[36:39], s58 offen nt
  s_add_u32 s58, s58, 8192
  buffer_load_dwordx4 v[160:163], v13, s[36:39], s58 offen nt
  s_add_u32 s58, s58, 8192
  buffer_load_dwordx4 v[164:167], v13, s[36:39], s58 offen nt
  s_add_u32 s58, s58, 8192
  buffer_load_dwordx4 v[168:171], v13, s[36:39], s58 offen nt
  s_add_u32 s58, s58, 8192
  buffer_load_dwordx4 v[172:175], v13, s[36:39], s58 offen nt
  s_add_u32 s58, s58, 8192
  buffer_load_dwordx4 v[176:179], v13, s[36:39], s58 offen nt
  s_add_u32 s58, s58, 8192
  buffer_load_dwordx4 v[180:183], v13, s[36:39], s58 offen nt
  s_add_u32 s58, s58, 8192
  buffer_load_dwordx4 v[184:187], v13, s[36:39], s58 offen nt
  s_add_u32 s58, s58, 8192
  buffer_load_dwordx4 v[188:191], v13, s[36:39], s58 offen nt
  s_add_u32 s58, s58, 8192
  buffer_load_dwordx4 v[192:195], v13, s[36:39], s58 offen nt
  s_add_u32 s58, s58, 8192
  buffer_load_dwordx4 v[196:199], v13, s[36:39], s58 offen nt
  s_add_u32 s58, s58, 8192
  buffer_load_dwordx4 v[200:203], v13, s[36:39], s58 offen nt
  s_add_u32 s58, s58, 8192
  buffer_load_dwordx4 v[204:207], v13, s[36:39], s58 offen nt
  s_add_u32 s58, s58, 8192
  buffer_load_dwordx4 v[208:211], v13, s[36:39], s58 offen nt
  s_mov_b64 s[28:29], s[18:19]
  s_mov_b64 s[40:41], s[12:13]
  s_mov_b64 s[44:45], s[14:15]
  s_load_dword s51, s[18:19], 0
  s_cmp_ge_u32 s49, 3
  s_cbranch_scc1 L_noinitp
  s_lshl_b32 s61, s48, 2
  s_add_u32 s61, s61, s49
  s_lshl_b32 s61, s61, 8
  s_add_u32 s61, s61, 196608
  s_add_u32 s70, s18, s61
  s_addc_u32 s71, s19, 0
  s_mov_b32 s65, 0
  s_atomic_swap s65, s[70:71], 0 glc
L_noinitp:
  v_mov_b32 v44, 0
  v_mov_b32 v45, 0
  v_mov_b32 v46, 0
  v_mov_b32 v47, 0
  v_mov_b32 v48, 0
  v_mov_b32 v49, 0
  v_mov_b32 v50, 0
  v_mov_b32 v51, 0
  v_lshlrev_b32 v15, 5, v15
  v_lshrrev_b32 v16, 4, v0
  v_lshl_add_u32 v15, v16, 3, v15
  v_add_u32 v15, s59, v15
  s_waitcnt vmcnt(16)
  v_and_b32 v20, 0xffff, v36
  v_lshlrev_b32 v21, 16, v36
  v_lshrrev_b32 v22, 16, v36
  v_and_b32 v23, 0xffff0000, v36
  v_and_b32 v24, 0xffff, v37
  v_lshlrev_b32 v25, 16, v37
  s_waitcnt vmcnt(15)
  v_dot2_f32_bf16 v44, v148, v20, v44
  v_dot2_f32_bf16 v45, v148, v21, v45
  v_dot2_f32_bf16 v46, v149, v20, v46
  v_dot2_f32_bf16 v47, v149, v21, v47
  v_dot2_f32_bf16 v48, v150, v20, v48
  v_dot2_f32_bf16 v49, v150, v21, v49
  v_dot2_f32_bf16 v50, v151, v20, v50
  v_dot2_f32_bf16 v51, v151, v21, v51
  v_lshrrev_b32 v26, 16, v37
  v_and_b32 v27, 0xffff0000, v37
  s_waitcnt vmcnt(14)
  v_dot2_f32_bf16 v44, v152, v22, v44
  v_dot2_f32_bf16 v45, v152, v23, v45
  v_dot2_f32_bf16 v46, v153, v22, v46
  v_dot2_f32_bf16 v47, v153, v23, v47
  v_dot2_f32_bf16 v48, v154, v22, v48
  v_dot2_f32_bf16 v49, v154, v23, v49
  v_dot2_f32_bf16 v50, v155, v22, v50
  v_dot2_f32_bf16 v51, v155, v23, v51
  v_and_b32 v20, 0xffff, v38
  v_lshlrev_b32 v21, 16, v38
  s_waitcnt vmcnt(13)
  v_dot2_f32_bf16 v44, v156, v24, v44
  v_dot2_f32_bf16 v45, v156, v25, v45
  v_dot2_f32_bf16 v46, v157, v24, v46
  v_dot2_f32_bf16 v47, v157, v25, v47
  v_dot2_f32_bf16 v48, v158, v24, v48
  v_dot2_f32_bf16 v49, v158, v25, v49
  v_dot2_f32_bf16 v50, v159, v24, v50
  v_dot2_f32_bf16 v51, v159, v25, v51
  v_lshrrev_b32 v22, 16, v38
  v_and_b32 v23, 0xffff0000, v38
  s_waitcnt vmcnt(12)
  v_dot2_f32_bf16 v44, v160, v26, v44
  v_dot2_f32_bf16 v45, v160, v27, v45
  v_dot2_f32_bf16 v46, v161, v26, v46
  v_dot2_f32_bf16 v47, v161, v27, v47
  v_dot2_f32_bf16 v48, v162, v26, v48
  v_dot2_f32_bf16 v49, v162, v27, v49
  v_dot2_f32_bf16 v50, v163, v26, v50
  v_dot2_f32_bf16 v51, v163, v27, v51
  v_and_b32 v24, 0xffff, v39
  v_lshlrev_b32 v25, 16, v39
  s_waitcnt vmcnt(11)
  v_dot2_f32_bf16 v44, v164, v20, v44
  v_dot2_f32_bf16 v45, v164, v21, v45
  v_dot2_f32_bf16 v46, v165, v20, v46
  v_dot2_f32_bf16 v47, v165, v21, v47
  v_dot2_f32_bf16 v48, v166, v20, v48
  v_dot2_f32_bf16 v49, v166, v21, v49
  v_dot2_f32_bf16 v50, v167, v20, v50
  v_dot2_f32_bf16 v51, v167, v21, v51
  v_lshrrev_b32 v26, 16, v39
  v_and_b32 v27, 0xffff0000, v39
  s_waitcnt vmcnt(10)
  v_dot2_f32_bf16 v44, v168, v22, v44
  v_dot2_f32_bf16 v45, v168, v23, v45
  v_dot2_f32_bf16 v46, v169, v22, v46
  v_dot2_f32_bf16 v47, v169, v23, v47
  v_dot2_f32_bf16 v48, v170, v22, v48
  v_dot2_f32_bf16 v49, v170, v23, v49
  v_dot2_f32_bf16 v50, v171, v22, v50
  v_dot2_f32_bf16 v51, v171, v23, v51
  v_and_b32 v20, 0xffff, v40
  v_lshlrev_b32 v21, 16, v40
  s_waitcnt vmcnt(9)
  v_dot2_f32_bf16 v44, v172, v24, v44
  v_dot2_f32_bf16 v45, v172, v25, v45
  v_dot2_f32_bf16 v46, v173, v24, v46
  v_dot2_f32_bf16 v47, v173, v25, v47
  v_dot2_f32_bf16 v48, v174, v24, v48
  v_dot2_f32_bf16 v49, v174, v25, v49
  v_dot2_f32_bf16 v50, v175, v24, v50
  v_dot2_f32_bf16 v51, v175, v25, v51
  v_lshrrev_b32 v22, 16, v40
  v_and_b32 v23, 0xffff0000, v40
  s_waitcnt vmcnt(8)
  v_dot2_f32_bf16 v44, v176, v26, v44
  v_dot2_f32_bf16 v45, v176, v27, v45
  v_dot2_f32_bf16 v46, v177, v26, v46
  v_dot2_f32_bf16 v47, v177, v27, v47
  v_dot2_f32_bf16 v48, v178, v26, v48
  v_dot2_f32_bf16 v49, v178, v27, v49
  v_dot2_f32_bf16 v50, v179, v26, v50
  v_dot2_f32_bf16 v51, v179, v27, v51
  v_and_b32 v24, 0xffff, v41
  v_lshlrev_b32 v25, 16, v41
  s_waitcnt vmcnt(7)
  v_dot2_f32_bf16 v44, v180, v20, v44
  v_dot2_f32_bf16 v45, v180, v21, v45
  v_dot2_f32_bf16 v46, v181, v20, v46
  v_dot2_f32_bf16 v47, v181, v21, v47
  v_dot2_f32_bf16 v48, v182, v20, v48
  v_dot2_f32_bf16 v49, v182, v21, v49
  v_dot2_f32_bf16 v50, v183, v20, v50
  v_dot2_f32_bf16 v51, v183, v21, v51
  v_lshrrev_b32 v26, 16, v41
  v_and_b32 v27, 0xffff0000, v41
  s_waitcnt vmcnt(6)
  v_dot2_f32_bf16 v44, v184, v22, v44
  v_dot2_f32_bf16 v45, v184, v23, v45
  v_dot2_f32_bf16 v46, v185, v22, v46
  v_dot2_f32_bf16 v47, v185, v23, v47
  v_dot2_f32_bf16 v48, v186, v22, v48
  v_dot2_f32_bf16 v49, v186, v23, v49
  v_dot2_f32_bf16 v50, v187, v22, v50
  v_dot2_f32_bf16 v51, v187, v23, v51
  v_and_b32 v20, 0xffff, v42
  v_lshlrev_b32 v21, 16, v42
  s_waitcnt vmcnt(5)
  v_dot2_f32_bf16 v44, v188, v24, v44
  v_dot2_f32_bf16 v45, v188, v25, v45
  v_dot2_f32_bf16 v46, v189, v24, v46
  v_dot2_f32_bf16 v47, v189, v25, v47
  v_dot2_f32_bf16 v48, v190, v24, v48
  v_dot2_f32_bf16 v49, v190, v25, v49
  v_dot2_f32_bf16 v50, v191, v24, v50
  v_dot2_f32_bf16 v51, v191, v25, v51
  v_lshrrev_b32 v22, 16, v42
  v_and_b32 v23, 0xffff0000, v42
  s_waitcnt vmcnt(4)
  v_dot2_f32_bf16 v44, v192, v26, v44
  v_dot2_f32_bf16 v45, v192, v27, v45
  v_dot2_f32_bf16 v46, v193, v26, v46
  v_dot2_f32_bf16 v47, v193, v27, v47
  v_dot2_f32_bf16 v48, v194, v26, v48
  v_dot2_f32_bf16 v49, v194, v27, v49
  v_dot2_f32_bf16 v50, v195, v26, v50
  v_dot2_f32_bf16 v51, v195, v27, v51
  v_and_b32 v24, 0xffff, v43
  v_lshlrev_b32 v25, 16, v43
  s_waitcnt vmcnt(3)
  v_dot2_f32_bf16 v44, v196, v20, v44
  v_dot2_f32_bf16 v45, v196, v21, v45
  v_dot2_f32_bf16 v46, v197, v20, v46
  v_dot2_f32_bf16 v47, v197, v21, v47
  v_dot2_f32_bf16 v48, v198, v20, v48
  v_dot2_f32_bf16 v49, v198, v21, v49
  v_dot2_f32_bf16 v50, v199, v20, v50
  v_dot2_f32_bf16 v51, v199, v21, v51
  v_lshrrev_b32 v26, 16, v43
  v_and_b32 v27, 0xffff0000, v43
  s_waitcnt vmcnt(2)
  v_dot2_f32_bf16 v44, v200, v22, v44
  v_dot2_f32_bf16 v45, v200, v23, v45
  v_dot2_f32_bf16 v46, v201, v22, v46
  v_dot2_f32_bf16 v47, v201, v23, v47
  v_dot2_f32_bf16 v48, v202, v22, v48
  v_dot2_f32_bf16 v49, v202, v23, v49
  v_dot2_f32_bf16 v50, v203, v22, v50
  v_dot2_f32_bf16 v51, v203, v23, v51
  s_waitcnt vmcnt(1)
  v_dot2_f32_bf16 v44, v204, v24, v44
  v_dot2_f32_bf16 v45, v204, v25, v45
  v_dot2_f32_bf16 v46, v205, v24, v46
  v_dot2_f32_bf16 v47, v205, v25, v47
  v_dot2_f32_bf16 v48, v206, v24, v48
  v_dot2_f32_bf16 v49, v206, v25, v49
  v_dot2_f32_bf16 v50, v207, v24, v50
  v_dot2_f32_bf16 v51, v207, v25, v51
  s_waitcnt vmcnt(0)
  v_dot2_f32_bf16 v44, v208, v26, v44
  v_dot2_f32_bf16 v45, v208, v27, v45
  v_dot2_f32_bf16 v46, v209, v26, v46
  v_dot2_f32_bf16 v47, v209, v27, v47
  v_dot2_f32_bf16 v48, v210, v26, v48
  v_dot2_f32_bf16 v49, v210, v27, v49
  v_dot2_f32_bf16 v50, v211, v26, v50
  v_dot2_f32_bf16 v51, v211, v27, v51
  v_permlane32_swap_b32 v44, v48
  s_nop 0
  v_permlane32_swap_b32 v46, v50
  v_permlane32_swap_b32 v45, v49
  v_permlane32_swap_b32 v47, v51
  v_add_f32 v44, v44, v48
  v_add_f32 v46, v46, v50
  v_add_f32 v45, v45, v49
  v_add_f32 v47, v47, v51
  v_permlane16_swap_b32 v44, v46
  s_nop 0
  v_permlane16_swap_b32 v45, v47
  v_add_f32 v44, v44, v46
  v_add_f32 v45, v45, v47
  s_nop 0
  v_add_f32_dpp v44, v44, v44 row_ror:8 row_mask:0xf bank_mask:0xf
  v_add_f32_dpp v45, v45, v45 row_ror:8 row_mask:0xf bank_mask:0xf
  ds_write_b64 v15, v[44:45] offset:1280
  s_waitcnt lgkmcnt(0)
  s_barrier
L_svc:
  s_lshl_b32 s62, s48, 11
  s_add_u32 s62, s62, 524288
  s_cmp_ge_u32 s49, 8
  s_cbranch_scc1 L_snoq
  v_and_b32 v1, 31, v0
  v_lshlrev_b32 v1, 3, v1
  ds_read_b64 v[4:5], v1 offset:1280
  ds_read_b64 v[6:7], v1 offset:1536
  ds_read_b64 v[8:9], v1 offset:1792
  ds_read_b64 v[10:11], v1 offset:2048
  s_lshl_b32 s58, s49, 8
  s_add_u32 s58, s58, s62
  s_waitcnt lgkmcnt(0)
  s_add_u32 s59, s51, 1
  v_mov_b32 v3, s59
  v_add_f32 v4, v4, v6
  v_add_f32 v5, v5, v7
  v_add_f32 v8, v8, v10
  v_add_f32 v9, v9, v11
  v_add_f32 v4, v4, v8
  v_add_f32 v5, v5, v9
  v_cvt_pk_bf16_f32 v2, v4, v5
  s_mov_b32 exec_hi, 0
  buffer_store_dwordx2 v[2:3], v1, s[28:31], s58 offen sc1
  s_mov_b64 exec, -1
  s_barrier
  s_branch L_sq2
L_snoq:
  s_sleep 90
L_sq2:
  v_lshlrev_b32 v1, 5, v0
  v_and_b32 v4, 15, v0
  v_lshrrev_b32 v5, 4, v0
  v_bfe_u32 v6, v0, 2, 2
  v_and_b32 v7, 3, v0
  s_waitcnt lgkmcnt(0)
  s_add_u32 s51, s51, 1
  s_mov_b32 s64, 4000000
L_pq:
  buffer_load_dwordx4 v[12:15], v1, s[28:31], s62 offen sc1
  buffer_load_dwordx4 v[16:19], v1, s[28:31], s62 offen offset:16 sc1
  s_waitcnt vmcnt(0)
  v_cmpx_eq_u32 vcc, s51, v13
  v_cmpx_eq_u32 vcc, s51, v15
  v_cmpx_eq_u32 vcc, s51, v17
  v_cmpx_eq_u32 vcc, s51, v19
  s_cmp_eq_u64 exec, -1
  s_mov_b64 exec, -1
  s_cbranch_scc1 L_pq_ok
  s_sleep 8
  s_sub_u32 s64, s64, 1
  s_cmp_lg_u32 s64, 0
  s_cbranch_scc1 L_pq
L_pq_ok:
  s_nop 4
  v_mov_b32 v13, v14
  v_mov_b32 v14, v16
  v_mov_b32 v15, v18
  v_lshlrev_b32 v100, 4, v0
  ds_write_b128 v100, v[12:15] offset:0
  s_waitcnt lgkmcnt(0)
  s_barrier
  v_lshrrev_b32 v107, 2, v0
  v_lshlrev_b32 v107, 12, v107
  v_lshl_add_u32 v107, v7, 4, v107
  v_lshlrev_b32 v101, 3, v6
  v_lshlrev_b32 v102, 15, v6
  v_lshrrev_b32 v8, 1, v5
  v_lshl_add_u32 v102, v8, 14, v102
  v_and_b32 v8, 1, v5
  v_lshl_add_u32 v102, v8, 6, v102
  v_lshl_add_u32 v102, v7, 4, v102
  v_mov_b32 v59, s51
  v_mov_b32 v63, s51
  v_mov_b32 v67, s51
  v_mov_b32 v71, s51
  v_and_b32 v8, 1, v0
  v_cmp_eq_u32 s[72:73], 1, v8
  s_lshl_b32 s58, s48, 17
  s_lshl_b32 s59, s49, 7
  s_add_u32 s58, s58, s59
  s_add_u32 s58, s58, 1048576
  s_lshl_b32 s61, s2, 12
  s_add_u32 s61, s61, 1048576
  s_lshl_b32 s63, s48, 3
  s_add_u32 s63, s63, s49
  s_lshl_b32 s62, s63, 6
  s_add_u32 s62, s62, 2097152
  v_bfe_u32 v8, v0, 1, 1
  v_lshlrev_b32 v8, 4, v8
  v_mov_b32 v9, 0xffff
  v_lshlrev_b32 v8, v8, v9
  v_and_b32 v9, 1, v0
  v_lshlrev_b32 v9, 2, v9
  v_bfe_u32 v103, v0, 2, 2
  v_add_u32 v9, v9, v103
  v_cmp_eq_u32 vcc, 0, v9
  s_nop 1
  v_cndmask_b32 v108, 0, v8, vcc
  v_cmp_eq_u32 vcc, 1, v9
  s_nop 1
  v_cndmask_b32 v109, 0, v8, vcc
  v_cmp_eq_u32 vcc, 2, v9
  s_nop 1
  v_cndmask_b32 v110, 0, v8, vcc
  v_cmp_eq_u32 vcc, 3, v9
  s_nop 1
  v_cndmask_b32 v111, 0, v8, vcc
  v_and_b32 v8, 15, v0
  v_lshlrev_b32 v8, 2, v8
  v_lshrrev_b32 v9, 4, v0
  v_add_u32 v8, v8, v9
  v_lshlrev_b32 v103, 4, v8
  s_lshl_b32 s55, s2, 12
  s_lshl_b32 s56, s50, 10
  s_add_u32 s55, s55, s56
  s_add_u32 s55, s55, 2097152
  s_barrier
  ds_read_b64 v[44:45], v101 offset:1024
  ds_read_b64 v[46:47], v101 offset:1056
  ds_read_b64 v[48:49], v101 offset:1088
  ds_read_b128 v[12:15], v100 offset:2560
  ds_read_b128 v[16:19], v100 offset:3584
  ds_read_b128 v[20:23], v100 offset:4608
  ds_read_b128 v[24:27], v100 offset:5632
  ds_read_b128 v[28:31], v100 offset:6656
  ds_read_b128 v[32:35], v100 offset:7680
  s_waitcnt lgkmcnt(6)
  v_max3_f32 v72, v44, v46, v48
  v_sub_f32 v52, v44, v72
  v_sub_f32 v53, v46, v72
  v_sub_f32 v54, v48, v72
  v_exp_f32 v52, v52
  v_exp_f32 v53, v53
  v_exp_f32 v54, v54
  v_mul_f32 v74, v52, v45
  v_fmac_f32 v74, v53, v47
  v_fmac_f32 v74, v54, v49
  v_cndmask_b32 v58, v72, v74, s[72:73]
  s_waitcnt lgkmcnt(0)
  v_mul_f32 v56, v52, v12
  v_mul_f32 v57, v52, v16
  v_fmac_f32 v56, v53, v20
  v_fmac_f32 v57, v53, v24
  v_fmac_f32 v56, v54, v28
  v_fmac_f32 v57, v54, v32
  buffer_store_dwordx4 v[56:59], v102, s[28:31], s58 offen sc1
  s_add_u32 s58, s58, 4096
  v_mov_b32 v62, v58
  v_mul_f32 v60, v52, v13
  v_mul_f32 v61, v52, v17
  v_fmac_f32 v60, v53, v21
  v_fmac_f32 v61, v53, v25
  v_fmac_f32 v60, v54, v29
  v_fmac_f32 v61, v54, v33
  buffer_store_dwordx4 v[60:63], v102, s[28:31], s58 offen sc1
  s_add_u32 s58, s58, 4096
  v_mov_b32 v66, v58
  v_mul_f32 v64, v52, v14
  v_mul_f32 v65, v52, v18
  v_fmac_f32 v64, v53, v22
  v_fmac_f32 v65, v53, v26
  v_fmac_f32 v64, v54, v30
  v_fmac_f32 v65, v54, v34
  buffer_store_dwordx4 v[64:67], v102, s[28:31], s58 offen sc1
  s_add_u32 s58, s58, 4096
  v_mov_b32 v70, v58
  v_mul_f32 v68, v52, v15
  v_mul_f32 v69, v52, v19
  v_fmac_f32 v68, v53, v23
  v_fmac_f32 v69, v53, v27
  v_fmac_f32 v68, v54, v31
  v_fmac_f32 v69, v54, v35
  buffer_store_dwordx4 v[68:71], v102, s[28:31], s58 offen sc1
  v_lshrrev_b32 v8, 5, v0
  v_lshlrev_b32 v8, 12, v8
  v_bfe_u32 v9, v0, 4, 1
  v_lshl_add_u32 v8, v9, 15, v8
  v_and_b32 v9, 15, v0
  v_lshl_add_u32 v8, v9, 4, v8
  s_lshr_b32 s52, s2, 2
  s_lshl_b32 s52, s52, 16
  s_and_b32 s53, s2, 3
  s_lshl_b32 s53, s53, 13
  s_add_u32 s52, s52, s53
  s_lshl_b32 s53, s50, 8
  s_add_u32 s52, s52, s53
  buffer_load_dwordx4 v[116:119], v8, s[40:43], s52 offen offset:0 nt
  buffer_load_dwordx4 v[120:123], v8, s[40:43], s52 offen offset:1024 nt
  buffer_load_dwordx4 v[124:127], v8, s[40:43], s52 offen offset:2048 nt
  buffer_load_dwordx4 v[128:131], v8, s[40:43], s52 offen offset:3072 nt
  s_sleep 22
  s_mov_b32 s64, 4000000
L_pa:
  buffer_load_dwordx4 v[12:15], v100, s[28:31], s61 offen offset:0 sc1
  buffer_load_dwordx4 v[16:19], v100, s[28:31], s61 offen offset:1024 sc1
  buffer_load_dwordx4 v[20:23], v100, s[28:31], s61 offen offset:2048 sc1
  buffer_load_dwordx4 v[24:27], v100, s[28:31], s61 offen offset:3072 sc1
  s_waitcnt vmcnt(0)
  v_cmpx_eq_u32 vcc, s51, v15
  v_cmpx_eq_u32 vcc, s51, v19
  v_cmpx_eq_u32 vcc, s51, v23
  v_cmpx_eq_u32 vcc, s51, v27
  s_cmp_eq_u64 exec, -1
  s_mov_b64 exec, -1
  s_cbranch_scc1 L_pa_ok
  s_sleep 2
  s_sub_u32 s64, s64, 1
  s_cmp_lg_u32 s64, 0
  s_cbranch_scc1 L_pa
L_pa_ok:
  s_nop 4
  v_mov_b32_dpp v28, v14 quad_perm:[0,0,2,2] row_mask:0xf bank_mask:0xf
  v_mov_b32_dpp v30, v14 quad_perm:[1,1,3,3] row_mask:0xf bank_mask:0xf
  v_mov_b32_dpp v32, v18 quad_perm:[0,0,2,2] row_mask:0xf bank_mask:0xf
  v_mov_b32_dpp v34, v18 quad_perm:[1,1,3,3] row_mask:0xf bank_mask:0xf
  v_mov_b32_dpp v36, v22 quad_perm:[0,0,2,2] row_mask:0xf bank_mask:0xf
  v_mov_b32_dpp v38, v22 quad_perm:[1,1,3,3] row_mask:0xf bank_mask:0xf
  v_mov_b32_dpp v40, v26 quad_perm:[0,0,2,2] row_mask:0xf bank_mask:0xf
  v_mov_b32_dpp v42, v26 quad_perm:[1,1,3,3] row_mask:0xf bank_mask:0xf
  v_max3_f32 v44, v28, v32, v36
  v_max_f32 v44, v44, v40
  s_nop 1
  v_max_f32_dpp v44, v44, v44 row_ror:8 row_mask:0xf bank_mask:0xf
  v_mov_b32 v45, v44
  s_nop 1
  v_permlane32_swap_b32 v44, v45
  v_max_f32 v44, v44, v45
  v_mov_b32 v45, v44
  s_nop 1
  v_permlane16_swap_b32 v44, v45
  v_max_f32 v44, v44, v45
  v_sub_f32 v46, v28, v44
  v_sub_f32 v47, v32, v44
  v_sub_f32 v48, v36, v44
  v_sub_f32 v49, v40, v44
  v_exp_f32 v46, v46
  v_exp_f32 v47, v47
  v_exp_f32 v48, v48
  v_exp_f32 v49, v49
  v_mul_f32 v50, v46, v30
  v_mul_f32 v51, v46, v12
  v_mul_f32 v52, v46, v13
  v_fmac_f32 v50, v47, v34
  v_fmac_f32 v51, v47, v16
  v_fmac_f32 v52, v47, v17
  v_fmac_f32 v50, v48, v38
  v_fmac_f32 v51, v48, v20
  v_fmac_f32 v52, v48, v21
  v_fmac_f32 v50, v49, v42
  v_fmac_f32 v51, v49, v24
  v_fmac_f32 v52, v49, v25
  v_add_f32_dpp v50, v50, v50 row_ror:8 row_mask:0xf bank_mask:0xf
  v_add_f32_dpp v51, v51, v51 row_ror:8 row_mask:0xf bank_mask:0xf
  v_add_f32_dpp v52, v52, v52 row_ror:8 row_mask:0xf bank_mask:0xf
  v_mov_b32 v53, v50
  s_nop 0
  v_permlane32_swap_b32 v51, v52
  v_permlane32_swap_b32 v50, v53
  v_add_f32 v51, v51, v52
  v_add_f32 v50, v50, v53
  v_mov_b32 v52, v51
  v_mov_b32 v53, v50
  s_nop 0
  v_permlane16_swap_b32 v51, v52
  v_permlane16_swap_b32 v50, v53
  v_add_f32 v50, v50, v53
  v_add_f32 v51, v51, v52
  v_rcp_f32 v50, v50
  s_nop 0
  v_mul_f32_dpp v54, v51, v50 row_newbcast:0 row_mask:0x5 bank_mask:0xf
  v_mul_f32_dpp v54, v51, v50 row_newbcast:4 row_mask:0xa bank_mask:0xf
  v_mul_f32_dpp v55, v51, v50 row_newbcast:1 row_mask:0x5 bank_mask:0xf
  v_mul_f32_dpp v55, v51, v50 row_newbcast:5 row_mask:0xa bank_mask:0xf
  v_mul_f32_dpp v56, v51, v50 row_newbcast:2 row_mask:0x5 bank_mask:0xf
  v_mul_f32_dpp v56, v51, v50 row_newbcast:6 row_mask:0xa bank_mask:0xf
  v_mul_f32_dpp v57, v51, v50 row_newbcast:3 row_mask:0x5 bank_mask:0xf
  v_mul_f32_dpp v57, v51, v50 row_newbcast:7 row_mask:0xa bank_mask:0xf
  v_cvt_pk_bf16_f32 v54, v54, v54
  v_cvt_pk_bf16_f32 v55, v55, v55
  v_cvt_pk_bf16_f32 v56, v56, v56
  v_cvt_pk_bf16_f32 v57, v57, v57
  ds_write_b128 v100, v[54:57] offset:10752
  s_waitcnt lgkmcnt(0)
  s_barrier
  v_and_b32 v60, v54, v108
  v_and_b32 v61, v54, v109
  v_and_b32 v62, v54, v110
  v_and_b32 v63, v54, v111
  v_and_b32 v64, v55, v108
  v_and_b32 v65, v55, v109
  v_and_b32 v66, v55, v110
  v_and_b32 v67, v55, v111
  v_and_b32 v68, v56, v108
  v_and_b32 v69, v56, v109
  v_and_b32 v70, v56, v110
  v_and_b32 v71, v56, v111
  v_and_b32 v72, v57, v108
  v_and_b32 v73, v57, v109
  v_and_b32 v74, v57, v110
  v_and_b32 v75, v57, v111
  s_waitcnt vmcnt(0)
  v_mfma_f32_16x16x32_bf16 v[76:79], v[60:63], v[116:119], 0
  v_mfma_f32_16x16x32_bf16 v[76:79], v[64:67], v[120:123], v[76:79]
  v_mfma_f32_16x16x32_bf16 v[76:79], v[68:71], v[124:127], v[76:79]
  v_mfma_f32_16x16x32_bf16 v[76:79], v[72:75], v[128:131], v[76:79]
  s_nop 7
  v_mov_b32 v77, s51
  v_mov_b32 v79, s51
  buffer_store_dwordx4 v[76:79], v103, s[28:31], s55 offen sc1
  s_cmp_ge_u32 s49, 8
  s_cbranch_scc1 L_done
  v_lshlrev_b32 v3, 2, v0
  v_mov_b32 v1, 0
  v_mov_b32 v2, s51
  s_sleep 26
  s_waitcnt vmcnt(0)
  s_mov_b32 s64, 4000000
  s_mov_b32 s58, s62
  buffer_load_dwordx4 v[12:15], v107, s[28:31], s58 offen sc1
  s_add_u32 s58, s58, 65536
  buffer_load_dwordx4 v[16:19], v107, s[28:31], s58 offen sc1
  s_add_u32 s58, s58, 65536
  buffer_load_dwordx4 v[20:23], v107, s[28:31], s58 offen sc1
  s_add_u32 s58, s58, 65536
  buffer_load_dwordx4 v[24:27], v107, s[28:31], s58 offen sc1
  s_add_u32 s58, s58, 65536
  buffer_load_dwordx4 v[28:31], v107, s[28:31], s58 offen sc1
  s_add_u32 s58, s58, 65536
  buffer_load_dwordx4 v[32:35], v107, s[28:31], s58 offen sc1
  s_add_u32 s58, s58, 65536
  buffer_load_dwordx4 v[36:39], v107, s[28:31], s58 offen sc1
  s_add_u32 s58, s58, 65536
  buffer_load_dwordx4 v[40:43], v107, s[28:31], s58 offen sc1
  s_add_u32 s58, s58, 65536
  buffer_load_dwordx4 v[44:47], v107, s[28:31], s58 offen sc1
  s_add_u32 s58, s58, 65536
  buffer_load_dwordx4 v[48:51], v107, s[28:31], s58 offen sc1
  s_add_u32 s58, s58, 65536
  buffer_load_dwordx4 v[52:55], v107, s[28:31], s58 offen sc1
  s_add_u32 s58, s58, 65536
  buffer_load_dwordx4 v[56:59], v107, s[28:31], s58 offen sc1
  s_add_u32 s58, s58, 65536
  buffer_load_dwordx4 v[60:63], v107, s[28:31], s58 offen sc1
  s_add_u32 s58, s58, 65536
  buffer_load_dwordx4 v[64:67], v107, s[28:31], s58 offen sc1
  s_add_u32 s58, s58, 65536
  buffer_load_dwordx4 v[68:71], v107, s[28:31], s58 offen sc1
  s_add_u32 s58, s58, 65536
  buffer_load_dwordx4 v[72:75], v107, s[28:31], s58 offen sc1
  s_sleep 8
  s_mov_b32 s58, s62
  buffer_load_dwordx4 v[116:119], v107, s[28:31], s58 offen sc1
  s_add_u32 s58, s58, 65536
  buffer_load_dwordx4 v[120:123], v107, s[28:31], s58 offen sc1
  s_add_u32 s58, s58, 65536
  buffer_load_dwordx4 v[124:127], v107, s[28:31], s58 offen sc1
  s_add_u32 s58, s58, 65536
  buffer_load_dwordx4 v[128:131], v107, s[28:31], s58 offen sc1
  s_add_u32 s58, s58, 65536
  buffer_load_dwordx4 v[132:135], v107, s[28:31], s58 offen sc1
  s_add_u32 s58, s58, 65536
  buffer_load_dwordx4 v[136:139], v107, s[28:31], s58 offen sc1
  s_add_u32 s58, s58, 65536
  buffer_load_dwordx4 v[140:143], v107, s[28:31], s58 offen sc1
  s_add_u32 s58, s58, 65536
  buffer_load_dwordx4 v[144:147], v107, s[28:31], s58 offen sc1
  s_add_u32 s58, s58, 65536
  buffer_load_dwordx4 v[148:151], v107, s[28:31], s58 offen sc1
  s_add_u32 s58, s58, 65536
  buffer_load_dwordx4 v[152:155], v107, s[28:31], s58 offen sc1
  s_add_u32 s58, s58, 65536
  buffer_load_dwordx4 v[156:159], v107, s[28:31], s58 offen sc1
  s_add_u32 s58, s58, 65536
  buffer_load_dwordx4 v[160:163], v107, s[28:31], s58 offen sc1
  s_add_u32 s58, s58, 65536
  buffer_load_dwordx4 v[164:167], v107, s[28:31], s58 offen sc1
  s_add_u32 s58, s58, 65536
  buffer_load_dwordx4 v[168:171], v107, s[28:31], s58 offen sc1
  s_add_u32 s58, s58, 65536
  buffer_load_dwordx4 v[172:175], v107, s[28:31], s58 offen sc1
  s_add_u32 s58, s58, 65536
  buffer_load_dwordx4 v[176:179], v107, s[28:31], s58 offen sc1
L_pb:
  s_waitcnt vmcnt(16)
  v_cmpx_eq_u32 vcc, s51, v13
  v_cmpx_eq_u32 vcc, s51, v15
  v_cmpx_eq_u32 vcc, s51, v17
  v_cmpx_eq_u32 vcc, s51, v19
  v_cmpx_eq_u32 vcc, s51, v21
  v_cmpx_eq_u32 vcc, s51, v23
  v_cmpx_eq_u32 vcc, s51, v25
  v_cmpx_eq_u32 vcc, s51, v27
  v_cmpx_eq_u32 vcc, s51, v29
  v_cmpx_eq_u32 vcc, s51, v31
  v_cmpx_eq_u32 vcc, s51, v33
  v_cmpx_eq_u32 vcc, s51, v35
  v_cmpx_eq_u32 vcc, s51, v37
  v_cmpx_eq_u32 vcc, s51, v39
  v_cmpx_eq_u32 vcc, s51, v41
  v_cmpx_eq_u32 vcc, s51, v43
  v_cmpx_eq_u32 vcc, s51, v45
  v_cmpx_eq_u32 vcc, s51, v47
  v_cmpx_eq_u32 vcc, s51, v49
  v_cmpx_eq_u32 vcc, s51, v51
  v_cmpx_eq_u32 vcc, s51, v53
  v_cmpx_eq_u32 vcc, s51, v55
  v_cmpx_eq_u32 vcc, s51, v57
  v_cmpx_eq_u32 vcc, s51, v59
  v_cmpx_eq_u32 vcc, s51, v61
  v_cmpx_eq_u32 vcc, s51, v63
  v_cmpx_eq_u32 vcc, s51, v65
  v_cmpx_eq_u32 vcc, s51, v67
  v_cmpx_eq_u32 vcc, s51, v69
  v_cmpx_eq_u32 vcc, s51, v71
  v_cmpx_eq_u32 vcc, s51, v73
  v_cmpx_eq_u32 vcc, s51, v75
  s_cmp_eq_u64 exec, -1
  s_mov_b64 exec, -1
  s_cbranch_scc1 L_pb_ok0
  s_mov_b32 s58, s62
  buffer_load_dwordx4 v[12:15], v107, s[28:31], s58 offen sc1
  s_add_u32 s58, s58, 65536
  buffer_load_dwordx4 v[16:19], v107, s[28:31], s58 offen sc1
  s_add_u32 s58, s58, 65536
  buffer_load_dwordx4 v[20:23], v107, s[28:31], s58 offen sc1
  s_add_u32 s58, s58, 65536
  buffer_load_dwordx4 v[24:27], v107, s[28:31], s58 offen sc1
  s_add_u32 s58, s58, 65536
  buffer_load_dwordx4 v[28:31], v107, s[28:31], s58 offen sc1
  s_add_u32 s58, s58, 65536
  buffer_load_dwordx4 v[32:35], v107, s[28:31], s58 offen sc1
  s_add_u32 s58, s58, 65536
  buffer_load_dwordx4 v[36:39], v107, s[28:31], s58 offen sc1
  s_add_u32 s58, s58, 65536
  buffer_load_dwordx4 v[40:43], v107, s[28:31], s58 offen sc1
  s_add_u32 s58, s58, 65536
  buffer_load_dwordx4 v[44:47], v107, s[28:31], s58 offen sc1
  s_add_u32 s58, s58, 65536
  buffer_load_dwordx4 v[48:51], v107, s[28:31], s58 offen sc1
  s_add_u32 s58, s58, 65536
  buffer_load_dwordx4 v[52:55], v107, s[28:31], s58 offen sc1
  s_add_u32 s58, s58, 65536
  buffer_load_dwordx4 v[56:59], v107, s[28:31], s58 offen sc1
  s_add_u32 s58, s58, 65536
  buffer_load_dwordx4 v[60:63], v107, s[28:31], s58 offen sc1
  s_add_u32 s58, s58, 65536
  buffer_load_dwordx4 v[64:67], v107, s[28:31], s58 offen sc1
  s_add_u32 s58, s58, 65536
  buffer_load_dwordx4 v[68:71], v107, s[28:31], s58 offen sc1
  s_add_u32 s58, s58, 65536
  buffer_load_dwordx4 v[72:75], v107, s[28:31], s58 offen sc1
  s_waitcnt vmcnt(16)
  v_cmpx_eq_u32 vcc, s51, v117
  v_cmpx_eq_u32 vcc, s51, v119
  v_cmpx_eq_u32 vcc, s51, v121
  v_cmpx_eq_u32 vcc, s51, v123
  v_cmpx_eq_u32 vcc, s51, v125
  v_cmpx_eq_u32 vcc, s51, v127
  v_cmpx_eq_u32 vcc, s51, v129
  v_cmpx_eq_u32 vcc, s51, v131
  v_cmpx_eq_u32 vcc, s51, v133
  v_cmpx_eq_u32 vcc, s51, v135
  v_cmpx_eq_u32 vcc, s51, v137
  v_cmpx_eq_u32 vcc, s51, v139
  v_cmpx_eq_u32 vcc, s51, v141
  v_cmpx_eq_u32 vcc, s51, v143
  v_cmpx_eq_u32 vcc, s51, v145
  v_cmpx_eq_u32 vcc, s51, v147
  v_cmpx_eq_u32 vcc, s51, v149
  v_cmpx_eq_u32 vcc, s51, v151
  v_cmpx_eq_u32 vcc, s51, v153
  v_cmpx_eq_u32 vcc, s51, v155
  v_cmpx_eq_u32 vcc, s51, v157
  v_cmpx_eq_u32 vcc, s51, v159
  v_cmpx_eq_u32 vcc, s51, v161
  v_cmpx_eq_u32 vcc, s51, v163
  v_cmpx_eq_u32 vcc, s51, v165
  v_cmpx_eq_u32 vcc, s51, v167
  v_cmpx_eq_u32 vcc, s51, v169
  v_cmpx_eq_u32 vcc, s51, v171
  v_cmpx_eq_u32 vcc, s51, v173
  v_cmpx_eq_u32 vcc, s51, v175
  v_cmpx_eq_u32 vcc, s51, v177
  v_cmpx_eq_u32 vcc, s51, v179
  s_cmp_eq_u64 exec, -1
  s_mov_b64 exec, -1
  s_cbranch_scc1 L_pb_ok1
  s_mov_b32 s58, s62
  buffer_load_dwordx4 v[116:119], v107, s[28:31], s58 offen sc1
  s_add_u32 s58, s58, 65536
  buffer_load_dwordx4 v[120:123], v107, s[28:31], s58 offen sc1
  s_add_u32 s58, s58, 65536
  buffer_load_dwordx4 v[124:127], v107, s[28:31], s58 offen sc1
  s_add_u32 s58, s58, 65536
  buffer_load_dwordx4 v[128:131], v107, s[28:31], s58 offen sc1
  s_add_u32 s58, s58, 65536
  buffer_load_dwordx4 v[132:135], v107, s[28:31], s58 offen sc1
  s_add_u32 s58, s58, 65536
  buffer_load_dwordx4 v[136:139], v107, s[28:31], s58 offen sc1
  s_add_u32 s58, s58, 65536
  buffer_load_dwordx4 v[140:143], v107, s[28:31], s58 offen sc1
  s_add_u32 s58, s58, 65536
  buffer_load_dwordx4 v[144:147], v107, s[28:31], s58 offen sc1
  s_add_u32 s58, s58, 65536
  buffer_load_dwordx4 v[148:151], v107, s[28:31], s58 offen sc1
  s_add_u32 s58, s58, 65536
  buffer_load_dwordx4 v[152:155], v107, s[28:31], s58 offen sc1
  s_add_u32 s58, s58, 65536
  buffer_load_dwordx4 v[156:159], v107, s[28:31], s58 offen sc1
  s_add_u32 s58, s58, 65536
  buffer_load_dwordx4 v[160:163], v107, s[28:31], s58 offen sc1
  s_add_u32 s58, s58, 65536
  buffer_load_dwordx4 v[164:167], v107, s[28:31], s58 offen sc1
  s_add_u32 s58, s58, 65536
  buffer_load_dwordx4 v[168:171], v107, s[28:31], s58 offen sc1
  s_add_u32 s58, s58, 65536
  buffer_load_dwordx4 v[172:175], v107, s[28:31], s58 offen sc1
  s_add_u32 s58, s58, 65536
  buffer_load_dwordx4 v[176:179], v107, s[28:31], s58 offen sc1
  s_sub_u32 s64, s64, 1
  s_cmp_lg_u32 s64, 0
  s_cbranch_scc1 L_pb
L_pb_ok1:
  v_add_f32 v80, v116, v120
  v_add_f32 v81, v118, v122
  v_add_f32 v82, v124, v128
  v_add_f32 v83, v126, v130
  v_add_f32 v84, v132, v136
  v_add_f32 v85, v134, v138
  v_add_f32 v86, v140, v144
  v_add_f32 v87, v142, v146
  v_add_f32 v88, v148, v152
  v_add_f32 v89, v150, v154
  v_add_f32 v90, v156, v160
  v_add_f32 v91, v158, v162
  v_add_f32 v92, v164, v168
  v_add_f32 v93, v166, v170
  v_add_f32 v94, v172, v176
  v_add_f32 v95, v174, v178
  s_branch L_pb_done
L_pb_ok0:
  v_add_f32 v80, v12, v16
  v_add_f32 v81, v14, v18
  v_add_f32 v82, v20, v24
  v_add_f32 v83, v22, v26
  v_add_f32 v84, v28, v32
  v_add_f32 v85, v30, v34
  v_add_f32 v86, v36, v40
  v_add_f32 v87, v38, v42
  v_add_f32 v88, v44, v48
  v_add_f32 v89, v46, v50
  v_add_f32 v90, v52, v56
  v_add_f32 v91, v54, v58
  v_add_f32 v92, v60, v64
  v_add_f32 v93, v62, v66
  v_add_f32 v94, v68, v72
  v_add_f32 v95, v70, v74
L_pb_done:
  s_nop 4
  v_add_f32 v80, v80, v82
  v_add_f32 v81, v81, v83
  v_add_f32 v84, v84, v86
  v_add_f32 v85, v85, v87
  v_add_f32 v88, v88, v90
  v_add_f32 v89, v89, v91
  v_add_f32 v92, v92, v94
  v_add_f32 v93, v93, v95
  v_add_f32 v80, v80, v84
  v_add_f32 v81, v81, v85
  v_add_f32 v88, v88, v92
  v_add_f32 v89, v89, v93
  v_add_f32 v80, v80, v88
  v_add_f32 v81, v81, v89
  s_nop 0
  v_add_f32_dpp v80, v80, v80 row_ror:4 row_mask:0xf bank_mask:0xf
  v_add_f32_dpp v81, v81, v81 row_ror:4 row_mask:0xf bank_mask:0xf
  s_nop 0
  v_add_f32_dpp v80, v80, v80 row_ror:8 row_mask:0xf bank_mask:0xf
  v_add_f32_dpp v81, v81, v81 row_ror:8 row_mask:0xf bank_mask:0xf
  s_nop 1
  v_permlane32_swap_b32 v80, v81
  v_add_f32 v80, v80, v81
  v_mov_b32 v81, v80
  s_nop 1
  v_permlane16_swap_b32 v80, v81
  v_add_f32 v80, v80, v81
  v_mov_b32 v81, v80
  s_nop 1
  v_permlane32_swap_b32 v80, v81
  v_cvt_pk_bf16_f32 v96, v80, v81
  s_lshl_b32 s58, s63, 4
  s_mov_b64 exec, 0xf
  buffer_store_dword v96, v3, s[44:47], s58 offen sc1
  s_mov_b64 exec, 1
  s_cmp_lg_u32 s2, 0
  s_cbranch_scc1 L_noep
  buffer_store_dword v2, v1, s[28:31], 0 offen offset:0 sc1
L_noep:
L_done:
  s_endpgm
L_end:
  s_endpgm
.section .rodata,"a"
.p2align 6
.amdhsa_kernel standalone__gqa_block_cached__decode_kernel
  .amdhsa_next_free_vgpr 212
  .amdhsa_next_free_sgpr 96
  .amdhsa_accum_offset 212
  .amdhsa_group_segment_fixed_size 0
  .amdhsa_kernarg_size 64
  .amdhsa_user_sgpr_count 2
  .amdhsa_user_sgpr_kernarg_segment_ptr 1
  .amdhsa_system_sgpr_workgroup_id_x 1
  .amdhsa_float_denorm_mode_32 3
.end_amdhsa_kernel
```
